```python
import torch

def _softmax(x, axis=-1):
    return torch.softmax(x, dim=axis)
def _gelu(x):
    return torch.nn.functional.gelu(x, approximate="tanh")
def _silu(x):
    return torch.nn.functional.silu(x)
def _sigmoid(x):
    return torch.sigmoid(x)
def _layernorm(x, axis=-1, eps=1e-5):
    m = x.mean(dim=axis, keepdim=True)
    v = x.var(dim=axis, keepdim=True, unbiased=False)
    return (x - m) / torch.sqrt(v + eps)
def _scatter_add(tgt, idx, src, axis=0):
    return tgt.clone().index_add_(axis, idx, src)
def _segment_sum(src, seg, n):
    out = torch.zeros((n,) + src.shape[1:], dtype=src.dtype)
    return out.index_add_(0, seg, src)
def _pad(x, pw):
    flat = tuple(v for pair in reversed(pw) for v in pair)
    return torch.nn.functional.pad(x, flat)

kernel_name = 'gated_mix__compressed_kv_cla__swiglu_ffn__decode'

def setup_inputs():

    _w = (lambda a: (lambda t: t.to(torch.bfloat16) if t.is_floating_point() else t)(torch.as_tensor(a)))
    def _A_setup():
        B, H, Sq, Sk, D, M = 1, 32, 1, 8192, 128, 512
        Dc = 4 * D
        return {
            "x": _w((lambda *s: torch.randn(*s, dtype=torch.bfloat16) * 0.05)(B, Sq, M)),
            "c_kv": _w((lambda *s: torch.randn(*s, dtype=torch.bfloat16) * 0.8)(B, Sk, Dc)),
            "w_q": _w((lambda *s: torch.randn(*s, dtype=torch.bfloat16) * 6.4)(M, H, D) * (M ** -0.5)),
            "w_uk": _w((lambda *s: torch.randn(*s, dtype=torch.bfloat16) * 6.4)(Dc, H, D) * (Dc ** -0.5)),
            "w_uv": _w((lambda *s: torch.randn(*s, dtype=torch.bfloat16) * 0.8)(Dc, H, D) * (Dc ** -0.5)),
            "w_o": _w((lambda *s: torch.randn(*s, dtype=torch.bfloat16) * 0.8)(H, D, M) * ((H * D) ** -0.5)),
        }
    _A_in = _A_setup()

    def _B_setup():
        B, S, D, F = 1, 1, 512, 1376
        return {
            "x": _w((lambda *s: torch.randn(*s, dtype=torch.bfloat16) * 0.05)(B, S, D)),
            "w_gate": _w((lambda *s: torch.randn(*s, dtype=torch.bfloat16) * 0.1)(D, F)),
            "w_up": _w((lambda *s: torch.randn(*s, dtype=torch.bfloat16) * 0.1)(D, F)),
            "w_down": _w((lambda *s: torch.randn(*s, dtype=torch.bfloat16) * 0.1)(F, D)),
        }
    _B_in = _B_setup()

    return {
        "A_x": _A_in["x"],
        "A_c_kv": _A_in["c_kv"],
        "A_w_q": _A_in["w_q"],
        "A_w_uk": _A_in["w_uk"],
        "A_w_uv": _A_in["w_uv"],
        "A_w_o": _A_in["w_o"],
        "B_x": _B_in["x"],
        "B_w_gate": _B_in["w_gate"],
        "B_w_up": _B_in["w_up"],
        "B_w_down": _B_in["w_down"],
        "gate_w": _w((lambda *s: torch.randn(*s, dtype=torch.bfloat16) * 0.05)(512) * 16.0),
    }

def reference(A_x, A_c_kv, A_w_q, A_w_uk, A_w_uv, A_w_o, B_x, B_w_gate, B_w_up, B_w_down, gate_w):
    def _A_ref(x, c_kv, w_q, w_uk, w_uv, w_o):
        B, Sq, M = x.shape[0], x.shape[1], x.shape[2]
        Sk = c_kv.shape[1]
        H, D = w_q.shape[1], w_q.shape[2]
        q = torch.einsum("bqm,mhd->bhqd", x, w_q)
        k = torch.einsum("bkc,chd->bhkd", c_kv, w_uk)
        v = torch.einsum("bkc,chd->bhkd", c_kv, w_uv)
        scores = torch.einsum("bhqd,bhkd->bhqk", q, k) * (D ** -0.5)
        off = Sk - Sq
        qi = torch.arange(Sq)[:, None]
        kj = torch.arange(Sk)[None, :]
        cmask = kj <= (qi + off)
        scores = torch.where(cmask[None, None], scores, -1e9)
        p = _softmax(scores, axis=-1)
        ctx = torch.einsum("bhqk,bhkd->bhqd", p, v)
        return torch.einsum("bhqd,hdm->bqm", ctx, w_o)

    def _B_ref(x, w_gate, w_up, w_down):
        g = _silu(x @ w_gate)
        u = x @ w_up
        return (g * u) @ w_down

    x = A_x
    g = _sigmoid((x * gate_w).sum(-1, keepdims=True))
    a = _A_ref(x, A_c_kv, A_w_q, A_w_uk, A_w_uv, A_w_o)
    b = _B_ref(x, B_w_gate, B_w_up, B_w_down)
    return g * a + (1 - g) * b
```

```asm
; @launch kernel=ka_kernel grid=(432,1,1) block=(256,1,1) lds=16384
; @launch kernel=k3_kernel grid=(216,1,1) block=(256,1,1) lds=108032
; @launch kernel=k4_kernel grid=(256,1,1) block=(256,1,1) lds=20480
; @launch kernel=k5_kernel grid=(256,1,1) block=(256,1,1) lds=16384
; @launch kernel=k6_kernel grid=(2,1,1) block=(256,1,1) lds=0
.amdgcn_target "amdgcn-amd-amdhsa--gfx950"
.text
.globl ka_kernel
.p2align 8
.type ka_kernel,@function
ka_kernel:
    s_cmp_ge_u32 s2, 432
    s_cbranch_scc1 ka_kernel_end
    s_load_dwordx16 s[16:31], s[0:1], 0
    s_load_dwordx8 s[32:39], s[0:1], 64
    s_load_dwordx4 s[40:43], s[0:1], 96
    s_waitcnt lgkmcnt(0)
    s_mov_b32 s48, s42
    s_mov_b32 s49, s43
    s_mov_b32 s50, 16777216
    s_mov_b32 s51, 0x00020000
    s_cmp_ge_u32 s2, 256
    s_cbranch_scc1 ka_ffn
    s_and_b32 s57, s2, 31
    s_lshr_b32 s60, s2, 5
    s_mov_b32 s44, s22
    s_mov_b32 s45, s23
    s_mov_b32 s46, 4194304
    s_mov_b32 s47, 0x00020000
    s_mov_b32 s64, s20
    s_mov_b32 s65, s21
    s_mov_b32 s66, 4194304
    s_mov_b32 s67, 0x00020000
    s_mov_b32 s68, s16
    s_mov_b32 s69, s17
    s_mov_b32 s70, 1024
    s_mov_b32 s71, 0x00020000
    v_lshrrev_b32 v1, 4, v0
    v_and_b32 v2, 15, v0
    v_lshlrev_b32 v5, 4, v0
    buffer_load_dwordx4 v[8:11], v5, s[68:71], 0 offen
    s_lshl_b32 s63, s57, 8
    v_lshlrev_b32 v5, 13, v1
    v_lshl_add_u32 v5, v2, 4, v5
    v_add_u32 v5, s63, v5
    buffer_load_dwordx4 v[128:131], v5, s[64:67], 0 offen
    v_add_u32 v5, 0x20000, v5
    buffer_load_dwordx4 v[132:135], v5, s[64:67], 0 offen
    v_add_u32 v5, 0x20000, v5
    buffer_load_dwordx4 v[136:139], v5, s[64:67], 0 offen
    v_add_u32 v5, 0x20000, v5
    buffer_load_dwordx4 v[140:143], v5, s[64:67], 0 offen
    v_add_u32 v5, 0x20000, v5
    buffer_load_dwordx4 v[144:147], v5, s[64:67], 0 offen
    v_add_u32 v5, 0x20000, v5
    buffer_load_dwordx4 v[148:151], v5, s[64:67], 0 offen
    v_add_u32 v5, 0x20000, v5
    buffer_load_dwordx4 v[152:155], v5, s[64:67], 0 offen
    v_add_u32 v5, 0x20000, v5
    buffer_load_dwordx4 v[156:159], v5, s[64:67], 0 offen
    v_add_u32 v5, 0x20000, v5
    buffer_load_dwordx4 v[160:163], v5, s[64:67], 0 offen
    v_add_u32 v5, 0x20000, v5
    buffer_load_dwordx4 v[164:167], v5, s[64:67], 0 offen
    v_add_u32 v5, 0x20000, v5
    buffer_load_dwordx4 v[168:171], v5, s[64:67], 0 offen
    v_add_u32 v5, 0x20000, v5
    buffer_load_dwordx4 v[172:175], v5, s[64:67], 0 offen
    v_add_u32 v5, 0x20000, v5
    buffer_load_dwordx4 v[176:179], v5, s[64:67], 0 offen
    v_add_u32 v5, 0x20000, v5
    buffer_load_dwordx4 v[180:183], v5, s[64:67], 0 offen
    v_add_u32 v5, 0x20000, v5
    buffer_load_dwordx4 v[184:187], v5, s[64:67], 0 offen
    v_add_u32 v5, 0x20000, v5
    buffer_load_dwordx4 v[188:191], v5, s[64:67], 0 offen
    v_add_u32 v5, 0x20000, v5
    buffer_load_dwordx4 v[192:195], v5, s[64:67], 0 offen
    v_add_u32 v5, 0x20000, v5
    buffer_load_dwordx4 v[196:199], v5, s[64:67], 0 offen
    v_add_u32 v5, 0x20000, v5
    buffer_load_dwordx4 v[200:203], v5, s[64:67], 0 offen
    v_add_u32 v5, 0x20000, v5
    buffer_load_dwordx4 v[204:207], v5, s[64:67], 0 offen
    v_add_u32 v5, 0x20000, v5
    buffer_load_dwordx4 v[208:211], v5, s[64:67], 0 offen
    v_add_u32 v5, 0x20000, v5
    buffer_load_dwordx4 v[212:215], v5, s[64:67], 0 offen
    v_add_u32 v5, 0x20000, v5
    buffer_load_dwordx4 v[216:219], v5, s[64:67], 0 offen
    v_add_u32 v5, 0x20000, v5
    buffer_load_dwordx4 v[220:223], v5, s[64:67], 0 offen
    v_add_u32 v5, 0x20000, v5
    buffer_load_dwordx4 v[224:227], v5, s[64:67], 0 offen
    v_add_u32 v5, 0x20000, v5
    buffer_load_dwordx4 v[228:231], v5, s[64:67], 0 offen
    v_add_u32 v5, 0x20000, v5
    buffer_load_dwordx4 v[232:235], v5, s[64:67], 0 offen
    v_add_u32 v5, 0x20000, v5
    buffer_load_dwordx4 v[236:239], v5, s[64:67], 0 offen
    v_add_u32 v5, 0x20000, v5
    buffer_load_dwordx4 v[240:243], v5, s[64:67], 0 offen
    v_add_u32 v5, 0x20000, v5
    buffer_load_dwordx4 v[244:247], v5, s[64:67], 0 offen
    v_add_u32 v5, 0x20000, v5
    buffer_load_dwordx4 v[248:251], v5, s[64:67], 0 offen
    v_add_u32 v5, 0x20000, v5
    buffer_load_dwordx4 v[252:255], v5, s[64:67], 0 offen
    s_lshl_b32 s62, s60, 6
    v_add_u32 v5, s62, v1
    v_lshlrev_b32 v5, 13, v5
    v_lshl_add_u32 v5, v2, 4, v5
    v_add_u32 v5, s63, v5
    buffer_load_dwordx4 v[80:83], v5, s[44:47], 0 offen
    v_add_u32 v5, 0x20000, v5
    buffer_load_dwordx4 v[84:87], v5, s[44:47], 0 offen
    v_add_u32 v5, 0x20000, v5
    buffer_load_dwordx4 v[88:91], v5, s[44:47], 0 offen
    v_add_u32 v5, 0x20000, v5
    buffer_load_dwordx4 v[92:95], v5, s[44:47], 0 offen
    s_waitcnt vmcnt(36)
    v_lshlrev_b32 v12, 16, v8
    v_and_b32 v13, 0xffff0000, v8
    v_lshlrev_b32 v14, 16, v9
    v_and_b32 v15, 0xffff0000, v9
    v_lshlrev_b32 v16, 16, v10
    v_and_b32 v17, 0xffff0000, v10
    v_lshlrev_b32 v18, 16, v11
    v_and_b32 v19, 0xffff0000, v11
    v_lshlrev_b32 v4, 5, v0
    v_cmp_gt_u32 vcc, 64, v0
    s_and_saveexec_b64 s[58:59], vcc
    ds_write_b128 v4, v[12:15] offset:12288
    ds_write_b128 v4, v[16:19] offset:12304
    s_mov_b64 exec, s[58:59]
    s_waitcnt lgkmcnt(0)
    s_barrier
    v_lshlrev_b32 v4, 2, v1
    ds_read_b32 v44, v4 offset:12288
    ds_read_b32 v45, v4 offset:12352
    ds_read_b32 v46, v4 offset:12416
    ds_read_b32 v47, v4 offset:12480
    ds_read_b32 v48, v4 offset:12544
    ds_read_b32 v49, v4 offset:12608
    ds_read_b32 v50, v4 offset:12672
    ds_read_b32 v51, v4 offset:12736
    ds_read_b32 v52, v4 offset:12800
    ds_read_b32 v53, v4 offset:12864
    ds_read_b32 v54, v4 offset:12928
    ds_read_b32 v55, v4 offset:12992
    ds_read_b32 v56, v4 offset:13056
    ds_read_b32 v57, v4 offset:13120
    ds_read_b32 v58, v4 offset:13184
    ds_read_b32 v59, v4 offset:13248
    ds_read_b32 v60, v4 offset:13312
    ds_read_b32 v61, v4 offset:13376
    ds_read_b32 v62, v4 offset:13440
    ds_read_b32 v63, v4 offset:13504
    ds_read_b32 v64, v4 offset:13568
    ds_read_b32 v65, v4 offset:13632
    ds_read_b32 v66, v4 offset:13696
    ds_read_b32 v67, v4 offset:13760
    ds_read_b32 v68, v4 offset:13824
    ds_read_b32 v69, v4 offset:13888
    ds_read_b32 v70, v4 offset:13952
    ds_read_b32 v71, v4 offset:14016
    ds_read_b32 v72, v4 offset:14080
    ds_read_b32 v73, v4 offset:14144
    ds_read_b32 v74, v4 offset:14208
    ds_read_b32 v75, v4 offset:14272
    v_mov_b32 v28, 0
    v_mov_b32 v29, 0
    v_mov_b32 v30, 0
    v_mov_b32 v31, 0
    v_mov_b32 v32, 0
    v_mov_b32 v33, 0
    v_mov_b32 v34, 0
    v_mov_b32 v35, 0
    s_waitcnt vmcnt(35) lgkmcnt(0)
    v_lshlrev_b32 v36, 16, v128
    v_and_b32 v37, 0xffff0000, v128
    v_fmac_f32 v28, v36, v44
    v_fmac_f32 v29, v37, v44
    v_lshlrev_b32 v36, 16, v129
    v_and_b32 v37, 0xffff0000, v129
    v_fmac_f32 v30, v36, v44
    v_fmac_f32 v31, v37, v44
    v_lshlrev_b32 v36, 16, v130
    v_and_b32 v37, 0xffff0000, v130
    v_fmac_f32 v32, v36, v44
    v_fmac_f32 v33, v37, v44
    v_lshlrev_b32 v36, 16, v131
    v_and_b32 v37, 0xffff0000, v131
    v_fmac_f32 v34, v36, v44
    v_fmac_f32 v35, v37, v44
    s_waitcnt vmcnt(34)
    v_lshlrev_b32 v36, 16, v132
    v_and_b32 v37, 0xffff0000, v132
    v_fmac_f32 v28, v36, v45
    v_fmac_f32 v29, v37, v45
    v_lshlrev_b32 v36, 16, v133
    v_and_b32 v37, 0xffff0000, v133
    v_fmac_f32 v30, v36, v45
    v_fmac_f32 v31, v37, v45
    v_lshlrev_b32 v36, 16, v134
    v_and_b32 v37, 0xffff0000, v134
    v_fmac_f32 v32, v36, v45
    v_fmac_f32 v33, v37, v45
    v_lshlrev_b32 v36, 16, v135
    v_and_b32 v37, 0xffff0000, v135
    v_fmac_f32 v34, v36, v45
    v_fmac_f32 v35, v37, v45
    s_waitcnt vmcnt(33)
    v_lshlrev_b32 v36, 16, v136
    v_and_b32 v37, 0xffff0000, v136
    v_fmac_f32 v28, v36, v46
    v_fmac_f32 v29, v37, v46
    v_lshlrev_b32 v36, 16, v137
    v_and_b32 v37, 0xffff0000, v137
    v_fmac_f32 v30, v36, v46
    v_fmac_f32 v31, v37, v46
    v_lshlrev_b32 v36, 16, v138
    v_and_b32 v37, 0xffff0000, v138
    v_fmac_f32 v32, v36, v46
    v_fmac_f32 v33, v37, v46
    v_lshlrev_b32 v36, 16, v139
    v_and_b32 v37, 0xffff0000, v139
    v_fmac_f32 v34, v36, v46
    v_fmac_f32 v35, v37, v46
    s_waitcnt vmcnt(32)
    v_lshlrev_b32 v36, 16, v140
    v_and_b32 v37, 0xffff0000, v140
    v_fmac_f32 v28, v36, v47
    v_fmac_f32 v29, v37, v47
    v_lshlrev_b32 v36, 16, v141
    v_and_b32 v37, 0xffff0000, v141
    v_fmac_f32 v30, v36, v47
    v_fmac_f32 v31, v37, v47
    v_lshlrev_b32 v36, 16, v142
    v_and_b32 v37, 0xffff0000, v142
    v_fmac_f32 v32, v36, v47
    v_fmac_f32 v33, v37, v47
    v_lshlrev_b32 v36, 16, v143
    v_and_b32 v37, 0xffff0000, v143
    v_fmac_f32 v34, v36, v47
    v_fmac_f32 v35, v37, v47
    s_waitcnt vmcnt(31)
    v_lshlrev_b32 v36, 16, v144
    v_and_b32 v37, 0xffff0000, v144
    v_fmac_f32 v28, v36, v48
    v_fmac_f32 v29, v37, v48
    v_lshlrev_b32 v36, 16, v145
    v_and_b32 v37, 0xffff0000, v145
    v_fmac_f32 v30, v36, v48
    v_fmac_f32 v31, v37, v48
    v_lshlrev_b32 v36, 16, v146
    v_and_b32 v37, 0xffff0000, v146
    v_fmac_f32 v32, v36, v48
    v_fmac_f32 v33, v37, v48
    v_lshlrev_b32 v36, 16, v147
    v_and_b32 v37, 0xffff0000, v147
    v_fmac_f32 v34, v36, v48
    v_fmac_f32 v35, v37, v48
    s_waitcnt vmcnt(30)
    v_lshlrev_b32 v36, 16, v148
    v_and_b32 v37, 0xffff0000, v148
    v_fmac_f32 v28, v36, v49
    v_fmac_f32 v29, v37, v49
    v_lshlrev_b32 v36, 16, v149
    v_and_b32 v37, 0xffff0000, v149
    v_fmac_f32 v30, v36, v49
    v_fmac_f32 v31, v37, v49
    v_lshlrev_b32 v36, 16, v150
    v_and_b32 v37, 0xffff0000, v150
    v_fmac_f32 v32, v36, v49
    v_fmac_f32 v33, v37, v49
    v_lshlrev_b32 v36, 16, v151
    v_and_b32 v37, 0xffff0000, v151
    v_fmac_f32 v34, v36, v49
    v_fmac_f32 v35, v37, v49
    s_waitcnt vmcnt(29)
    v_lshlrev_b32 v36, 16, v152
    v_and_b32 v37, 0xffff0000, v152
    v_fmac_f32 v28, v36, v50
    v_fmac_f32 v29, v37, v50
    v_lshlrev_b32 v36, 16, v153
    v_and_b32 v37, 0xffff0000, v153
    v_fmac_f32 v30, v36, v50
    v_fmac_f32 v31, v37, v50
    v_lshlrev_b32 v36, 16, v154
    v_and_b32 v37, 0xffff0000, v154
    v_fmac_f32 v32, v36, v50
    v_fmac_f32 v33, v37, v50
    v_lshlrev_b32 v36, 16, v155
    v_and_b32 v37, 0xffff0000, v155
    v_fmac_f32 v34, v36, v50
    v_fmac_f32 v35, v37, v50
    s_waitcnt vmcnt(28)
    v_lshlrev_b32 v36, 16, v156
    v_and_b32 v37, 0xffff0000, v156
    v_fmac_f32 v28, v36, v51
    v_fmac_f32 v29, v37, v51
    v_lshlrev_b32 v36, 16, v157
    v_and_b32 v37, 0xffff0000, v157
    v_fmac_f32 v30, v36, v51
    v_fmac_f32 v31, v37, v51
    v_lshlrev_b32 v36, 16, v158
    v_and_b32 v37, 0xffff0000, v158
    v_fmac_f32 v32, v36, v51
    v_fmac_f32 v33, v37, v51
    v_lshlrev_b32 v36, 16, v159
    v_and_b32 v37, 0xffff0000, v159
    v_fmac_f32 v34, v36, v51
    v_fmac_f32 v35, v37, v51
    s_waitcnt vmcnt(27)
    v_lshlrev_b32 v36, 16, v160
    v_and_b32 v37, 0xffff0000, v160
    v_fmac_f32 v28, v36, v52
    v_fmac_f32 v29, v37, v52
    v_lshlrev_b32 v36, 16, v161
    v_and_b32 v37, 0xffff0000, v161
    v_fmac_f32 v30, v36, v52
    v_fmac_f32 v31, v37, v52
    v_lshlrev_b32 v36, 16, v162
    v_and_b32 v37, 0xffff0000, v162
    v_fmac_f32 v32, v36, v52
    v_fmac_f32 v33, v37, v52
    v_lshlrev_b32 v36, 16, v163
    v_and_b32 v37, 0xffff0000, v163
    v_fmac_f32 v34, v36, v52
    v_fmac_f32 v35, v37, v52
    s_waitcnt vmcnt(26)
    v_lshlrev_b32 v36, 16, v164
    v_and_b32 v37, 0xffff0000, v164
    v_fmac_f32 v28, v36, v53
    v_fmac_f32 v29, v37, v53
    v_lshlrev_b32 v36, 16, v165
    v_and_b32 v37, 0xffff0000, v165
    v_fmac_f32 v30, v36, v53
    v_fmac_f32 v31, v37, v53
    v_lshlrev_b32 v36, 16, v166
    v_and_b32 v37, 0xffff0000, v166
    v_fmac_f32 v32, v36, v53
    v_fmac_f32 v33, v37, v53
    v_lshlrev_b32 v36, 16, v167
    v_and_b32 v37, 0xffff0000, v167
    v_fmac_f32 v34, v36, v53
    v_fmac_f32 v35, v37, v53
    s_waitcnt vmcnt(25)
    v_lshlrev_b32 v36, 16, v168
    v_and_b32 v37, 0xffff0000, v168
    v_fmac_f32 v28, v36, v54
    v_fmac_f32 v29, v37, v54
    v_lshlrev_b32 v36, 16, v169
    v_and_b32 v37, 0xffff0000, v169
    v_fmac_f32 v30, v36, v54
    v_fmac_f32 v31, v37, v54
    v_lshlrev_b32 v36, 16, v170
    v_and_b32 v37, 0xffff0000, v170
    v_fmac_f32 v32, v36, v54
    v_fmac_f32 v33, v37, v54
    v_lshlrev_b32 v36, 16, v171
    v_and_b32 v37, 0xffff0000, v171
    v_fmac_f32 v34, v36, v54
    v_fmac_f32 v35, v37, v54
    s_waitcnt vmcnt(24)
    v_lshlrev_b32 v36, 16, v172
    v_and_b32 v37, 0xffff0000, v172
    v_fmac_f32 v28, v36, v55
    v_fmac_f32 v29, v37, v55
    v_lshlrev_b32 v36, 16, v173
    v_and_b32 v37, 0xffff0000, v173
    v_fmac_f32 v30, v36, v55
    v_fmac_f32 v31, v37, v55
    v_lshlrev_b32 v36, 16, v174
    v_and_b32 v37, 0xffff0000, v174
    v_fmac_f32 v32, v36, v55
    v_fmac_f32 v33, v37, v55
    v_lshlrev_b32 v36, 16, v175
    v_and_b32 v37, 0xffff0000, v175
    v_fmac_f32 v34, v36, v55
    v_fmac_f32 v35, v37, v55
    s_waitcnt vmcnt(23)
    v_lshlrev_b32 v36, 16, v176
    v_and_b32 v37, 0xffff0000, v176
    v_fmac_f32 v28, v36, v56
    v_fmac_f32 v29, v37, v56
    v_lshlrev_b32 v36, 16, v177
    v_and_b32 v37, 0xffff0000, v177
    v_fmac_f32 v30, v36, v56
    v_fmac_f32 v31, v37, v56
    v_lshlrev_b32 v36, 16, v178
    v_and_b32 v37, 0xffff0000, v178
    v_fmac_f32 v32, v36, v56
    v_fmac_f32 v33, v37, v56
    v_lshlrev_b32 v36, 16, v179
    v_and_b32 v37, 0xffff0000, v179
    v_fmac_f32 v34, v36, v56
    v_fmac_f32 v35, v37, v56
    s_waitcnt vmcnt(22)
    v_lshlrev_b32 v36, 16, v180
    v_and_b32 v37, 0xffff0000, v180
    v_fmac_f32 v28, v36, v57
    v_fmac_f32 v29, v37, v57
    v_lshlrev_b32 v36, 16, v181
    v_and_b32 v37, 0xffff0000, v181
    v_fmac_f32 v30, v36, v57
    v_fmac_f32 v31, v37, v57
    v_lshlrev_b32 v36, 16, v182
    v_and_b32 v37, 0xffff0000, v182
    v_fmac_f32 v32, v36, v57
    v_fmac_f32 v33, v37, v57
    v_lshlrev_b32 v36, 16, v183
    v_and_b32 v37, 0xffff0000, v183
    v_fmac_f32 v34, v36, v57
    v_fmac_f32 v35, v37, v57
    s_waitcnt vmcnt(21)
    v_lshlrev_b32 v36, 16, v184
    v_and_b32 v37, 0xffff0000, v184
    v_fmac_f32 v28, v36, v58
    v_fmac_f32 v29, v37, v58
    v_lshlrev_b32 v36, 16, v185
    v_and_b32 v37, 0xffff0000, v185
    v_fmac_f32 v30, v36, v58
    v_fmac_f32 v31, v37, v58
    v_lshlrev_b32 v36, 16, v186
    v_and_b32 v37, 0xffff0000, v186
    v_fmac_f32 v32, v36, v58
    v_fmac_f32 v33, v37, v58
    v_lshlrev_b32 v36, 16, v187
    v_and_b32 v37, 0xffff0000, v187
    v_fmac_f32 v34, v36, v58
    v_fmac_f32 v35, v37, v58
    s_waitcnt vmcnt(20)
    v_lshlrev_b32 v36, 16, v188
    v_and_b32 v37, 0xffff0000, v188
    v_fmac_f32 v28, v36, v59
    v_fmac_f32 v29, v37, v59
    v_lshlrev_b32 v36, 16, v189
    v_and_b32 v37, 0xffff0000, v189
    v_fmac_f32 v30, v36, v59
    v_fmac_f32 v31, v37, v59
    v_lshlrev_b32 v36, 16, v190
    v_and_b32 v37, 0xffff0000, v190
    v_fmac_f32 v32, v36, v59
    v_fmac_f32 v33, v37, v59
    v_lshlrev_b32 v36, 16, v191
    v_and_b32 v37, 0xffff0000, v191
    v_fmac_f32 v34, v36, v59
    v_fmac_f32 v35, v37, v59
    s_waitcnt vmcnt(19)
    v_lshlrev_b32 v36, 16, v192
    v_and_b32 v37, 0xffff0000, v192
    v_fmac_f32 v28, v36, v60
    v_fmac_f32 v29, v37, v60
    v_lshlrev_b32 v36, 16, v193
    v_and_b32 v37, 0xffff0000, v193
    v_fmac_f32 v30, v36, v60
    v_fmac_f32 v31, v37, v60
    v_lshlrev_b32 v36, 16, v194
    v_and_b32 v37, 0xffff0000, v194
    v_fmac_f32 v32, v36, v60
    v_fmac_f32 v33, v37, v60
    v_lshlrev_b32 v36, 16, v195
    v_and_b32 v37, 0xffff0000, v195
    v_fmac_f32 v34, v36, v60
    v_fmac_f32 v35, v37, v60
    s_waitcnt vmcnt(18)
    v_lshlrev_b32 v36, 16, v196
    v_and_b32 v37, 0xffff0000, v196
    v_fmac_f32 v28, v36, v61
    v_fmac_f32 v29, v37, v61
    v_lshlrev_b32 v36, 16, v197
    v_and_b32 v37, 0xffff0000, v197
    v_fmac_f32 v30, v36, v61
    v_fmac_f32 v31, v37, v61
    v_lshlrev_b32 v36, 16, v198
    v_and_b32 v37, 0xffff0000, v198
    v_fmac_f32 v32, v36, v61
    v_fmac_f32 v33, v37, v61
    v_lshlrev_b32 v36, 16, v199
    v_and_b32 v37, 0xffff0000, v199
    v_fmac_f32 v34, v36, v61
    v_fmac_f32 v35, v37, v61
    s_waitcnt vmcnt(17)
    v_lshlrev_b32 v36, 16, v200
    v_and_b32 v37, 0xffff0000, v200
    v_fmac_f32 v28, v36, v62
    v_fmac_f32 v29, v37, v62
    v_lshlrev_b32 v36, 16, v201
    v_and_b32 v37, 0xffff0000, v201
    v_fmac_f32 v30, v36, v62
    v_fmac_f32 v31, v37, v62
    v_lshlrev_b32 v36, 16, v202
    v_and_b32 v37, 0xffff0000, v202
    v_fmac_f32 v32, v36, v62
    v_fmac_f32 v33, v37, v62
    v_lshlrev_b32 v36, 16, v203
    v_and_b32 v37, 0xffff0000, v203
    v_fmac_f32 v34, v36, v62
    v_fmac_f32 v35, v37, v62
    s_waitcnt vmcnt(16)
    v_lshlrev_b32 v36, 16, v204
    v_and_b32 v37, 0xffff0000, v204
    v_fmac_f32 v28, v36, v63
    v_fmac_f32 v29, v37, v63
    v_lshlrev_b32 v36, 16, v205
    v_and_b32 v37, 0xffff0000, v205
    v_fmac_f32 v30, v36, v63
    v_fmac_f32 v31, v37, v63
    v_lshlrev_b32 v36, 16, v206
    v_and_b32 v37, 0xffff0000, v206
    v_fmac_f32 v32, v36, v63
    v_fmac_f32 v33, v37, v63
    v_lshlrev_b32 v36, 16, v207
    v_and_b32 v37, 0xffff0000, v207
    v_fmac_f32 v34, v36, v63
    v_fmac_f32 v35, v37, v63
    s_waitcnt vmcnt(15)
    v_lshlrev_b32 v36, 16, v208
    v_and_b32 v37, 0xffff0000, v208
    v_fmac_f32 v28, v36, v64
    v_fmac_f32 v29, v37, v64
    v_lshlrev_b32 v36, 16, v209
    v_and_b32 v37, 0xffff0000, v209
    v_fmac_f32 v30, v36, v64
    v_fmac_f32 v31, v37, v64
    v_lshlrev_b32 v36, 16, v210
    v_and_b32 v37, 0xffff0000, v210
    v_fmac_f32 v32, v36, v64
    v_fmac_f32 v33, v37, v64
    v_lshlrev_b32 v36, 16, v211
    v_and_b32 v37, 0xffff0000, v211
    v_fmac_f32 v34, v36, v64
    v_fmac_f32 v35, v37, v64
    s_waitcnt vmcnt(14)
    v_lshlrev_b32 v36, 16, v212
    v_and_b32 v37, 0xffff0000, v212
    v_fmac_f32 v28, v36, v65
    v_fmac_f32 v29, v37, v65
    v_lshlrev_b32 v36, 16, v213
    v_and_b32 v37, 0xffff0000, v213
    v_fmac_f32 v30, v36, v65
    v_fmac_f32 v31, v37, v65
    v_lshlrev_b32 v36, 16, v214
    v_and_b32 v37, 0xffff0000, v214
    v_fmac_f32 v32, v36, v65
    v_fmac_f32 v33, v37, v65
    v_lshlrev_b32 v36, 16, v215
    v_and_b32 v37, 0xffff0000, v215
    v_fmac_f32 v34, v36, v65
    v_fmac_f32 v35, v37, v65
    s_waitcnt vmcnt(13)
    v_lshlrev_b32 v36, 16, v216
    v_and_b32 v37, 0xffff0000, v216
    v_fmac_f32 v28, v36, v66
    v_fmac_f32 v29, v37, v66
    v_lshlrev_b32 v36, 16, v217
    v_and_b32 v37, 0xffff0000, v217
    v_fmac_f32 v30, v36, v66
    v_fmac_f32 v31, v37, v66
    v_lshlrev_b32 v36, 16, v218
    v_and_b32 v37, 0xffff0000, v218
    v_fmac_f32 v32, v36, v66
    v_fmac_f32 v33, v37, v66
    v_lshlrev_b32 v36, 16, v219
    v_and_b32 v37, 0xffff0000, v219
    v_fmac_f32 v34, v36, v66
    v_fmac_f32 v35, v37, v66
    s_waitcnt vmcnt(12)
    v_lshlrev_b32 v36, 16, v220
    v_and_b32 v37, 0xffff0000, v220
    v_fmac_f32 v28, v36, v67
    v_fmac_f32 v29, v37, v67
    v_lshlrev_b32 v36, 16, v221
    v_and_b32 v37, 0xffff0000, v221
    v_fmac_f32 v30, v36, v67
    v_fmac_f32 v31, v37, v67
    v_lshlrev_b32 v36, 16, v222
    v_and_b32 v37, 0xffff0000, v222
    v_fmac_f32 v32, v36, v67
    v_fmac_f32 v33, v37, v67
    v_lshlrev_b32 v36, 16, v223
    v_and_b32 v37, 0xffff0000, v223
    v_fmac_f32 v34, v36, v67
    v_fmac_f32 v35, v37, v67
    s_waitcnt vmcnt(11)
    v_lshlrev_b32 v36, 16, v224
    v_and_b32 v37, 0xffff0000, v224
    v_fmac_f32 v28, v36, v68
    v_fmac_f32 v29, v37, v68
    v_lshlrev_b32 v36, 16, v225
    v_and_b32 v37, 0xffff0000, v225
    v_fmac_f32 v30, v36, v68
    v_fmac_f32 v31, v37, v68
    v_lshlrev_b32 v36, 16, v226
    v_and_b32 v37, 0xffff0000, v226
    v_fmac_f32 v32, v36, v68
    v_fmac_f32 v33, v37, v68
    v_lshlrev_b32 v36, 16, v227
    v_and_b32 v37, 0xffff0000, v227
    v_fmac_f32 v34, v36, v68
    v_fmac_f32 v35, v37, v68
    s_waitcnt vmcnt(10)
    v_lshlrev_b32 v36, 16, v228
    v_and_b32 v37, 0xffff0000, v228
    v_fmac_f32 v28, v36, v69
    v_fmac_f32 v29, v37, v69
    v_lshlrev_b32 v36, 16, v229
    v_and_b32 v37, 0xffff0000, v229
    v_fmac_f32 v30, v36, v69
    v_fmac_f32 v31, v37, v69
    v_lshlrev_b32 v36, 16, v230
    v_and_b32 v37, 0xffff0000, v230
    v_fmac_f32 v32, v36, v69
    v_fmac_f32 v33, v37, v69
    v_lshlrev_b32 v36, 16, v231
    v_and_b32 v37, 0xffff0000, v231
    v_fmac_f32 v34, v36, v69
    v_fmac_f32 v35, v37, v69
    s_waitcnt vmcnt(9)
    v_lshlrev_b32 v36, 16, v232
    v_and_b32 v37, 0xffff0000, v232
    v_fmac_f32 v28, v36, v70
    v_fmac_f32 v29, v37, v70
    v_lshlrev_b32 v36, 16, v233
    v_and_b32 v37, 0xffff0000, v233
    v_fmac_f32 v30, v36, v70
    v_fmac_f32 v31, v37, v70
    v_lshlrev_b32 v36, 16, v234
    v_and_b32 v37, 0xffff0000, v234
    v_fmac_f32 v32, v36, v70
    v_fmac_f32 v33, v37, v70
    v_lshlrev_b32 v36, 16, v235
    v_and_b32 v37, 0xffff0000, v235
    v_fmac_f32 v34, v36, v70
    v_fmac_f32 v35, v37, v70
    s_waitcnt vmcnt(8)
    v_lshlrev_b32 v36, 16, v236
    v_and_b32 v37, 0xffff0000, v236
    v_fmac_f32 v28, v36, v71
    v_fmac_f32 v29, v37, v71
    v_lshlrev_b32 v36, 16, v237
    v_and_b32 v37, 0xffff0000, v237
    v_fmac_f32 v30, v36, v71
    v_fmac_f32 v31, v37, v71
    v_lshlrev_b32 v36, 16, v238
    v_and_b32 v37, 0xffff0000, v238
    v_fmac_f32 v32, v36, v71
    v_fmac_f32 v33, v37, v71
    v_lshlrev_b32 v36, 16, v239
    v_and_b32 v37, 0xffff0000, v239
    v_fmac_f32 v34, v36, v71
    v_fmac_f32 v35, v37, v71
    s_waitcnt vmcnt(7)
    v_lshlrev_b32 v36, 16, v240
    v_and_b32 v37, 0xffff0000, v240
    v_fmac_f32 v28, v36, v72
    v_fmac_f32 v29, v37, v72
    v_lshlrev_b32 v36, 16, v241
    v_and_b32 v37, 0xffff0000, v241
    v_fmac_f32 v30, v36, v72
    v_fmac_f32 v31, v37, v72
    v_lshlrev_b32 v36, 16, v242
    v_and_b32 v37, 0xffff0000, v242
    v_fmac_f32 v32, v36, v72
    v_fmac_f32 v33, v37, v72
    v_lshlrev_b32 v36, 16, v243
    v_and_b32 v37, 0xffff0000, v243
    v_fmac_f32 v34, v36, v72
    v_fmac_f32 v35, v37, v72
    s_waitcnt vmcnt(6)
    v_lshlrev_b32 v36, 16, v244
    v_and_b32 v37, 0xffff0000, v244
    v_fmac_f32 v28, v36, v73
    v_fmac_f32 v29, v37, v73
    v_lshlrev_b32 v36, 16, v245
    v_and_b32 v37, 0xffff0000, v245
    v_fmac_f32 v30, v36, v73
    v_fmac_f32 v31, v37, v73
    v_lshlrev_b32 v36, 16, v246
    v_and_b32 v37, 0xffff0000, v246
    v_fmac_f32 v32, v36, v73
    v_fmac_f32 v33, v37, v73
    v_lshlrev_b32 v36, 16, v247
    v_and_b32 v37, 0xffff0000, v247
    v_fmac_f32 v34, v36, v73
    v_fmac_f32 v35, v37, v73
    s_waitcnt vmcnt(5)
    v_lshlrev_b32 v36, 16, v248
    v_and_b32 v37, 0xffff0000, v248
    v_fmac_f32 v28, v36, v74
    v_fmac_f32 v29, v37, v74
    v_lshlrev_b32 v36, 16, v249
    v_and_b32 v37, 0xffff0000, v249
    v_fmac_f32 v30, v36, v74
    v_fmac_f32 v31, v37, v74
    v_lshlrev_b32 v36, 16, v250
    v_and_b32 v37, 0xffff0000, v250
    v_fmac_f32 v32, v36, v74
    v_fmac_f32 v33, v37, v74
    v_lshlrev_b32 v36, 16, v251
    v_and_b32 v37, 0xffff0000, v251
    v_fmac_f32 v34, v36, v74
    v_fmac_f32 v35, v37, v74
    s_waitcnt vmcnt(4)
    v_lshlrev_b32 v36, 16, v252
    v_and_b32 v37, 0xffff0000, v252
    v_fmac_f32 v28, v36, v75
    v_fmac_f32 v29, v37, v75
    v_lshlrev_b32 v36, 16, v253
    v_and_b32 v37, 0xffff0000, v253
    v_fmac_f32 v30, v36, v75
    v_fmac_f32 v31, v37, v75
    v_lshlrev_b32 v36, 16, v254
    v_and_b32 v37, 0xffff0000, v254
    v_fmac_f32 v32, v36, v75
    v_fmac_f32 v33, v37, v75
    v_lshlrev_b32 v36, 16, v255
    v_and_b32 v37, 0xffff0000, v255
    v_fmac_f32 v34, v36, v75
    v_fmac_f32 v35, v37, v75
    v_lshlrev_b32 v4, 9, v1
    v_lshl_add_u32 v4, v2, 5, v4
    ds_write_b128 v4, v[28:31] offset:1024
    ds_write_b128 v4, v[32:35] offset:1040
    s_waitcnt lgkmcnt(0)
    s_barrier
    v_and_b32 v4, 127, v0
    v_lshlrev_b32 v4, 2, v4
    ds_read_b32 v8, v4 offset:1024
    ds_read_b32 v9, v4 offset:1536
    ds_read_b32 v10, v4 offset:2048
    ds_read_b32 v11, v4 offset:2560
    ds_read_b32 v12, v4 offset:3072
    ds_read_b32 v13, v4 offset:3584
    ds_read_b32 v14, v4 offset:4096
    ds_read_b32 v15, v4 offset:4608
    ds_read_b32 v16, v4 offset:5120
    ds_read_b32 v17, v4 offset:5632
    ds_read_b32 v18, v4 offset:6144
    ds_read_b32 v19, v4 offset:6656
    ds_read_b32 v20, v4 offset:7168
    ds_read_b32 v21, v4 offset:7680
    ds_read_b32 v22, v4 offset:8192
    ds_read_b32 v23, v4 offset:8704
    s_waitcnt lgkmcnt(0)
    v_add_f32 v8, v8, v16
    v_add_f32 v9, v9, v17
    v_add_f32 v10, v10, v18
    v_add_f32 v11, v11, v19
    v_add_f32 v12, v12, v20
    v_add_f32 v13, v13, v21
    v_add_f32 v14, v14, v22
    v_add_f32 v15, v15, v23
    v_add_f32 v8, v8, v12
    v_add_f32 v9, v9, v13
    v_add_f32 v10, v10, v14
    v_add_f32 v11, v11, v15
    v_add_f32 v8, v8, v10
    v_add_f32 v9, v9, v11
    v_add_f32 v8, v8, v9
    v_cvt_pk_bf16_f32 v8, v8, v8
    v_lshlrev_b32 v8, 16, v8
    ds_write_b32 v4, v8
    s_waitcnt lgkmcnt(0)
    s_barrier
    v_lshlrev_b32 v4, 5, v2
    ds_read_b128 v[8:11], v4
    ds_read_b128 v[12:15], v4 offset:16
    s_waitcnt vmcnt(0) lgkmcnt(0)
    v_mov_b32 v100, 0
    v_lshlrev_b32 v36, 16, v80
    v_and_b32 v37, 0xffff0000, v80
    v_fmac_f32 v100, v36, v8
    v_fmac_f32 v100, v37, v9
    v_lshlrev_b32 v36, 16, v81
    v_and_b32 v37, 0xffff0000, v81
    v_fmac_f32 v100, v36, v10
    v_fmac_f32 v100, v37, v11
    v_lshlrev_b32 v36, 16, v82
    v_and_b32 v37, 0xffff0000, v82
    v_fmac_f32 v100, v36, v12
    v_fmac_f32 v100, v37, v13
    v_lshlrev_b32 v36, 16, v83
    v_and_b32 v37, 0xffff0000, v83
    v_fmac_f32 v100, v36, v14
    v_fmac_f32 v100, v37, v15
    v_mov_b32 v101, 0
    v_lshlrev_b32 v36, 16, v84
    v_and_b32 v37, 0xffff0000, v84
    v_fmac_f32 v101, v36, v8
    v_fmac_f32 v101, v37, v9
    v_lshlrev_b32 v36, 16, v85
    v_and_b32 v37, 0xffff0000, v85
    v_fmac_f32 v101, v36, v10
    v_fmac_f32 v101, v37, v11
    v_lshlrev_b32 v36, 16, v86
    v_and_b32 v37, 0xffff0000, v86
    v_fmac_f32 v101, v36, v12
    v_fmac_f32 v101, v37, v13
    v_lshlrev_b32 v36, 16, v87
    v_and_b32 v37, 0xffff0000, v87
    v_fmac_f32 v101, v36, v14
    v_fmac_f32 v101, v37, v15
    v_mov_b32 v102, 0
    v_lshlrev_b32 v36, 16, v88
    v_and_b32 v37, 0xffff0000, v88
    v_fmac_f32 v102, v36, v8
    v_fmac_f32 v102, v37, v9
    v_lshlrev_b32 v36, 16, v89
    v_and_b32 v37, 0xffff0000, v89
    v_fmac_f32 v102, v36, v10
    v_fmac_f32 v102, v37, v11
    v_lshlrev_b32 v36, 16, v90
    v_and_b32 v37, 0xffff0000, v90
    v_fmac_f32 v102, v36, v12
    v_fmac_f32 v102, v37, v13
    v_lshlrev_b32 v36, 16, v91
    v_and_b32 v37, 0xffff0000, v91
    v_fmac_f32 v102, v36, v14
    v_fmac_f32 v102, v37, v15
    v_mov_b32 v103, 0
    v_lshlrev_b32 v36, 16, v92
    v_and_b32 v37, 0xffff0000, v92
    v_fmac_f32 v103, v36, v8
    v_fmac_f32 v103, v37, v9
    v_lshlrev_b32 v36, 16, v93
    v_and_b32 v37, 0xffff0000, v93
    v_fmac_f32 v103, v36, v10
    v_fmac_f32 v103, v37, v11
    v_lshlrev_b32 v36, 16, v94
    v_and_b32 v37, 0xffff0000, v94
    v_fmac_f32 v103, v36, v12
    v_fmac_f32 v103, v37, v13
    v_lshlrev_b32 v36, 16, v95
    v_and_b32 v37, 0xffff0000, v95
    v_fmac_f32 v103, v36, v14
    v_fmac_f32 v103, v37, v15
    s_nop 1
    v_add_f32_dpp v100, v100, v100 row_ror:8 row_mask:0xf bank_mask:0xf
    v_add_f32_dpp v101, v101, v101 row_ror:8 row_mask:0xf bank_mask:0xf
    v_add_f32_dpp v102, v102, v102 row_ror:8 row_mask:0xf bank_mask:0xf
    v_add_f32_dpp v103, v103, v103 row_ror:8 row_mask:0xf bank_mask:0xf
    s_nop 1
    v_add_f32_dpp v100, v100, v100 row_ror:4 row_mask:0xf bank_mask:0xf
    v_add_f32_dpp v101, v101, v101 row_ror:4 row_mask:0xf bank_mask:0xf
    v_add_f32_dpp v102, v102, v102 row_ror:4 row_mask:0xf bank_mask:0xf
    v_add_f32_dpp v103, v103, v103 row_ror:4 row_mask:0xf bank_mask:0xf
    s_nop 1
    v_add_f32_dpp v100, v100, v100 row_ror:2 row_mask:0xf bank_mask:0xf
    v_add_f32_dpp v101, v101, v101 row_ror:2 row_mask:0xf bank_mask:0xf
    v_add_f32_dpp v102, v102, v102 row_ror:2 row_mask:0xf bank_mask:0xf
    v_add_f32_dpp v103, v103, v103 row_ror:2 row_mask:0xf bank_mask:0xf
    s_nop 1
    v_add_f32_dpp v100, v100, v100 row_ror:1 row_mask:0xf bank_mask:0xf
    v_add_f32_dpp v101, v101, v101 row_ror:1 row_mask:0xf bank_mask:0xf
    v_add_f32_dpp v102, v102, v102 row_ror:1 row_mask:0xf bank_mask:0xf
    v_add_f32_dpp v103, v103, v103 row_ror:1 row_mask:0xf bank_mask:0xf
    s_nop 1
    v_cvt_pk_bf16_f32 v100, v100, v100
    v_cvt_pk_bf16_f32 v101, v101, v101
    v_cvt_pk_bf16_f32 v102, v102, v102
    v_cvt_pk_bf16_f32 v103, v103, v103
    s_lshl_b32 s61, s57, 10
    s_add_u32 s61, s61, 524288
    s_lshl_b32 s62, s60, 7
    s_add_u32 s61, s61, s62
    v_lshl_add_u32 v5, v1, 1, s61
    v_cmp_eq_u32 vcc, 0, v2
    s_and_saveexec_b64 s[58:59], vcc
    buffer_store_short v100, v5, s[48:51], 0 offen offset:0
    buffer_store_short v101, v5, s[48:51], 0 offen offset:32
    buffer_store_short v102, v5, s[48:51], 0 offen offset:64
    buffer_store_short v103, v5, s[48:51], 0 offen offset:96
    s_branch ka_kernel_end
ka_ffn:
    s_sub_u32 s57, s2, 256
    s_cmp_ge_u32 s57, 88
    s_cselect_b32 s60, 1, 0
    s_cselect_b32 s44, s32, s30
    s_cselect_b32 s45, s33, s31
    s_mov_b32 s46, 1409024
    s_mov_b32 s47, 0x00020000
    s_mul_i32 s61, s60, 88
    s_sub_u32 s57, s57, s61
    s_mul_i32 s61, s57, 373
    s_lshr_b32 s61, s61, 12
    s_mul_i32 s62, s61, 11
    s_sub_u32 s62, s57, s62
    s_movk_i32 s52, 2752
    s_lshl_b32 s53, s61, 6
    s_lshl_b32 s54, s62, 8
    s_mul_i32 s55, s61, 11264
    s_mul_i32 s63, s60, 5632
    s_add_u32 s55, s55, s63
    s_lshl_b32 s63, s62, 9
    s_add_u32 s55, s55, s63
    s_add_u32 s55, s55, 262144
    s_mov_b32 s60, s16
    s_mov_b32 s61, s17
    s_mov_b32 s62, 1024
    s_mov_b32 s63, 0x00020000
    v_add_u32 v5, s53, v0
    v_lshlrev_b32 v5, 1, v5
    buffer_load_ushort v6, v5, s[60:63], 0 offen
    v_lshrrev_b32 v1, 4, v0
    v_and_b32 v2, 15, v0
    v_add_u32 v3, s53, v1
    v_mul_lo_u32 v3, v3, s52
    v_lshl_add_u32 v3, v2, 4, v3
    v_add_u32 v3, s54, v3
    s_lshl_b32 s56, s52, 4
    buffer_load_dwordx4 v[108:111], v3, s[44:47], 0 offen
    v_add_u32 v3, s56, v3
    buffer_load_dwordx4 v[112:115], v3, s[44:47], 0 offen
    v_add_u32 v3, s56, v3
    buffer_load_dwordx4 v[116:119], v3, s[44:47], 0 offen
    v_add_u32 v3, s56, v3
    buffer_load_dwordx4 v[120:123], v3, s[44:47], 0 offen
    v_lshlrev_b32 v4, 2, v0
    s_waitcnt vmcnt(4)
    v_lshlrev_b32 v6, 16, v6
    v_cmp_gt_u32 vcc, 64, v0
    s_and_saveexec_b64 s[58:59], vcc
    ds_write_b32 v4, v6
    s_mov_b64 exec, s[58:59]
    s_waitcnt lgkmcnt(0)
    s_barrier
    v_lshrrev_b32 v1, 4, v0
    v_and_b32 v2, 15, v0
    v_lshlrev_b32 v4, 2, v1
    ds_read_b32 v24, v4 offset:0
    ds_read_b32 v25, v4 offset:64
    ds_read_b32 v26, v4 offset:128
    ds_read_b32 v27, v4 offset:192
    v_mov_b32 v28, 0
    v_mov_b32 v29, 0
    v_mov_b32 v30, 0
    v_mov_b32 v31, 0
    v_mov_b32 v32, 0
    v_mov_b32 v33, 0
    v_mov_b32 v34, 0
    v_mov_b32 v35, 0
    s_waitcnt vmcnt(0) lgkmcnt(0)
    v_lshlrev_b32 v36, 16, v108
    v_and_b32 v37, 0xffff0000, v108
    v_fmac_f32 v28, v36, v24
    v_fmac_f32 v29, v37, v24
    v_lshlrev_b32 v36, 16, v109
    v_and_b32 v37, 0xffff0000, v109
    v_fmac_f32 v30, v36, v24
    v_fmac_f32 v31, v37, v24
    v_lshlrev_b32 v36, 16, v110
    v_and_b32 v37, 0xffff0000, v110
    v_fmac_f32 v32, v36, v24
    v_fmac_f32 v33, v37, v24
    v_lshlrev_b32 v36, 16, v111
    v_and_b32 v37, 0xffff0000, v111
    v_fmac_f32 v34, v36, v24
    v_fmac_f32 v35, v37, v24
    v_lshlrev_b32 v36, 16, v112
    v_and_b32 v37, 0xffff0000, v112
    v_fmac_f32 v28, v36, v25
    v_fmac_f32 v29, v37, v25
    v_lshlrev_b32 v36, 16, v113
    v_and_b32 v37, 0xffff0000, v113
    v_fmac_f32 v30, v36, v25
    v_fmac_f32 v31, v37, v25
    v_lshlrev_b32 v36, 16, v114
    v_and_b32 v37, 0xffff0000, v114
    v_fmac_f32 v32, v36, v25
    v_fmac_f32 v33, v37, v25
    v_lshlrev_b32 v36, 16, v115
    v_and_b32 v37, 0xffff0000, v115
    v_fmac_f32 v34, v36, v25
    v_fmac_f32 v35, v37, v25
    v_lshlrev_b32 v36, 16, v116
    v_and_b32 v37, 0xffff0000, v116
    v_fmac_f32 v28, v36, v26
    v_fmac_f32 v29, v37, v26
    v_lshlrev_b32 v36, 16, v117
    v_and_b32 v37, 0xffff0000, v117
    v_fmac_f32 v30, v36, v26
    v_fmac_f32 v31, v37, v26
    v_lshlrev_b32 v36, 16, v118
    v_and_b32 v37, 0xffff0000, v118
    v_fmac_f32 v32, v36, v26
    v_fmac_f32 v33, v37, v26
    v_lshlrev_b32 v36, 16, v119
    v_and_b32 v37, 0xffff0000, v119
    v_fmac_f32 v34, v36, v26
    v_fmac_f32 v35, v37, v26
    v_lshlrev_b32 v36, 16, v120
    v_and_b32 v37, 0xffff0000, v120
    v_fmac_f32 v28, v36, v27
    v_fmac_f32 v29, v37, v27
    v_lshlrev_b32 v36, 16, v121
    v_and_b32 v37, 0xffff0000, v121
    v_fmac_f32 v30, v36, v27
    v_fmac_f32 v31, v37, v27
    v_lshlrev_b32 v36, 16, v122
    v_and_b32 v37, 0xffff0000, v122
    v_fmac_f32 v32, v36, v27
    v_fmac_f32 v33, v37, v27
    v_lshlrev_b32 v36, 16, v123
    v_and_b32 v37, 0xffff0000, v123
    v_fmac_f32 v34, v36, v27
    v_fmac_f32 v35, v37, v27
    v_lshlrev_b32 v4, 9, v1
    v_lshl_add_u32 v4, v2, 5, v4
    ds_write_b128 v4, v[28:31] offset:1024
    ds_write_b128 v4, v[32:35] offset:1040
    s_waitcnt lgkmcnt(0)
    s_barrier
    v_cmp_gt_u32 vcc, 128, v0
    s_and_saveexec_b64 s[58:59], vcc
    s_cbranch_execz ka_kernel_end
    v_lshlrev_b32 v4, 2, v0
    ds_read_b32 v8, v4 offset:1024
    ds_read_b32 v9, v4 offset:1536
    ds_read_b32 v10, v4 offset:2048
    ds_read_b32 v11, v4 offset:2560
    ds_read_b32 v12, v4 offset:3072
    ds_read_b32 v13, v4 offset:3584
    ds_read_b32 v14, v4 offset:4096
    ds_read_b32 v15, v4 offset:4608
    ds_read_b32 v16, v4 offset:5120
    ds_read_b32 v17, v4 offset:5632
    ds_read_b32 v18, v4 offset:6144
    ds_read_b32 v19, v4 offset:6656
    ds_read_b32 v20, v4 offset:7168
    ds_read_b32 v21, v4 offset:7680
    ds_read_b32 v22, v4 offset:8192
    ds_read_b32 v23, v4 offset:8704
    s_waitcnt lgkmcnt(0)
    v_add_f32 v8, v8, v16
    v_add_f32 v9, v9, v17
    v_add_f32 v10, v10, v18
    v_add_f32 v11, v11, v19
    v_add_f32 v12, v12, v20
    v_add_f32 v13, v13, v21
    v_add_f32 v14, v14, v22
    v_add_f32 v15, v15, v23
    v_add_f32 v8, v8, v12
    v_add_f32 v9, v9, v13
    v_add_f32 v10, v10, v14
    v_add_f32 v11, v11, v15
    v_add_f32 v8, v8, v10
    v_add_f32 v9, v9, v11
    v_add_f32 v8, v8, v9
    v_add_u32 v4, s55, v4
    buffer_store_dword v8, v4, s[48:51], 0 offen
ka_kernel_end:
    s_endpgm
.globl k3_kernel
.p2align 8
.type k3_kernel,@function
k3_kernel:
    s_cmp_ge_u32 s2, 216
    s_cbranch_scc1 k3_kernel_end
    s_load_dwordx16 s[16:31], s[0:1], 0
    s_load_dwordx8 s[32:39], s[0:1], 64
    s_load_dwordx4 s[40:43], s[0:1], 96
    s_waitcnt lgkmcnt(0)
    s_mov_b32 s48, s42
    s_mov_b32 s49, s43
    s_mov_b32 s50, 16777216
    s_mov_b32 s51, 0x00020000
    s_cmp_ge_u32 s2, 128
    s_cbranch_scc0 k3_att
    s_sub_u32 s57, s2, 128
    s_and_b32 s62, s57, 3
    s_lshr_b32 s61, s57, 2
    s_mov_b32 s44, s34
    s_mov_b32 s45, s35
    s_mov_b32 s46, 1409024
    s_mov_b32 s47, 0x00020000
    s_movk_i32 s52, 1024
    s_lshl_b32 s53, s61, 6
    s_lshl_b32 s54, s62, 8
    s_lshl_b32 s55, s61, 11
    s_lshl_b32 s63, s62, 9
    s_add_u32 s55, s55, s63
    s_add_u32 s55, s55, 655360
    v_lshrrev_b32 v1, 4, v0
    v_and_b32 v2, 15, v0
    v_add_u32 v3, s53, v1
    v_mul_lo_u32 v3, v3, s52
    v_lshl_add_u32 v3, v2, 4, v3
    v_add_u32 v3, s54, v3
    s_lshl_b32 s56, s52, 4
    buffer_load_dwordx4 v[108:111], v3, s[44:47], 0 offen
    v_add_u32 v3, s56, v3
    buffer_load_dwordx4 v[112:115], v3, s[44:47], 0 offen
    v_add_u32 v3, s56, v3
    buffer_load_dwordx4 v[116:119], v3, s[44:47], 0 offen
    v_add_u32 v3, s56, v3
    buffer_load_dwordx4 v[120:123], v3, s[44:47], 0 offen
    v_add_u32 v5, s53, v0
    v_lshlrev_b32 v6, 2, v5
    v_add_u32 v6, 262144, v6
    buffer_load_dword v8, v6, s[48:51], 0 offen
    v_add_u32 v7, 5632, v6
    buffer_load_dword v16, v7, s[48:51], 0 offen
    v_add_u32 v6, 11264, v6
    buffer_load_dword v9, v6, s[48:51], 0 offen
    v_add_u32 v7, 5632, v6
    buffer_load_dword v17, v7, s[48:51], 0 offen
    v_add_u32 v6, 11264, v6
    buffer_load_dword v10, v6, s[48:51], 0 offen
    v_add_u32 v7, 5632, v6
    buffer_load_dword v18, v7, s[48:51], 0 offen
    v_add_u32 v6, 11264, v6
    buffer_load_dword v11, v6, s[48:51], 0 offen
    v_add_u32 v7, 5632, v6
    buffer_load_dword v19, v7, s[48:51], 0 offen
    v_add_u32 v6, 11264, v6
    buffer_load_dword v12, v6, s[48:51], 0 offen
    v_add_u32 v7, 5632, v6
    buffer_load_dword v20, v7, s[48:51], 0 offen
    v_add_u32 v6, 11264, v6
    buffer_load_dword v13, v6, s[48:51], 0 offen
    v_add_u32 v7, 5632, v6
    buffer_load_dword v21, v7, s[48:51], 0 offen
    v_add_u32 v6, 11264, v6
    buffer_load_dword v14, v6, s[48:51], 0 offen
    v_add_u32 v7, 5632, v6
    buffer_load_dword v22, v7, s[48:51], 0 offen
    v_add_u32 v6, 11264, v6
    buffer_load_dword v15, v6, s[48:51], 0 offen
    v_add_u32 v7, 5632, v6
    buffer_load_dword v23, v7, s[48:51], 0 offen
    s_waitcnt vmcnt(0)
    v_add_f32 v8, v8, v9
    v_add_f32 v16, v16, v17
    v_add_f32 v8, v8, v10
    v_add_f32 v16, v16, v18
    v_add_f32 v8, v8, v11
    v_add_f32 v16, v16, v19
    v_add_f32 v8, v8, v12
    v_add_f32 v16, v16, v20
    v_add_f32 v8, v8, v13
    v_add_f32 v16, v16, v21
    v_add_f32 v8, v8, v14
    v_add_f32 v16, v16, v22
    v_add_f32 v8, v8, v15
    v_add_f32 v16, v16, v23
    v_cvt_pk_bf16_f32 v8, v8, v8
    v_lshlrev_b32 v8, 16, v8
    v_cvt_pk_bf16_f32 v16, v16, v16
    v_lshlrev_b32 v16, 16, v16
    v_mul_f32 v9, 0xbfb8aa3b, v8
    v_exp_f32 v9, v9
    s_nop 0
    v_add_f32 v9, 1.0, v9
    v_rcp_f32 v9, v9
    s_nop 0
    v_mul_f32 v9, v8, v9
    v_cvt_pk_bf16_f32 v9, v9, v9
    v_lshlrev_b32 v9, 16, v9
    v_mul_f32 v9, v9, v16
    v_cvt_pk_bf16_f32 v9, v9, v9
    v_lshlrev_b32 v9, 16, v9
    v_cmp_gt_u32 vcc, 1376, v5
    s_nop 1
    v_cndmask_b32 v9, 0, v9, vcc
    v_lshlrev_b32 v4, 2, v0
    v_cmp_gt_u32 vcc, 64, v0
    s_and_saveexec_b64 s[58:59], vcc
    ds_write_b32 v4, v9
    s_mov_b64 exec, s[58:59]
    s_waitcnt lgkmcnt(0)
    s_barrier
    v_lshrrev_b32 v1, 4, v0
    v_and_b32 v2, 15, v0
    v_lshlrev_b32 v4, 2, v1
    ds_read_b32 v24, v4 offset:0
    ds_read_b32 v25, v4 offset:64
    ds_read_b32 v26, v4 offset:128
    ds_read_b32 v27, v4 offset:192
    v_mov_b32 v28, 0
    v_mov_b32 v29, 0
    v_mov_b32 v30, 0
    v_mov_b32 v31, 0
    v_mov_b32 v32, 0
    v_mov_b32 v33, 0
    v_mov_b32 v34, 0
    v_mov_b32 v35, 0
    s_waitcnt vmcnt(0) lgkmcnt(0)
    v_lshlrev_b32 v36, 16, v108
    v_and_b32 v37, 0xffff0000, v108
    v_fmac_f32 v28, v36, v24
    v_fmac_f32 v29, v37, v24
    v_lshlrev_b32 v36, 16, v109
    v_and_b32 v37, 0xffff0000, v109
    v_fmac_f32 v30, v36, v24
    v_fmac_f32 v31, v37, v24
    v_lshlrev_b32 v36, 16, v110
    v_and_b32 v37, 0xffff0000, v110
    v_fmac_f32 v32, v36, v24
    v_fmac_f32 v33, v37, v24
    v_lshlrev_b32 v36, 16, v111
    v_and_b32 v37, 0xffff0000, v111
    v_fmac_f32 v34, v36, v24
    v_fmac_f32 v35, v37, v24
    v_lshlrev_b32 v36, 16, v112
    v_and_b32 v37, 0xffff0000, v112
    v_fmac_f32 v28, v36, v25
    v_fmac_f32 v29, v37, v25
    v_lshlrev_b32 v36, 16, v113
    v_and_b32 v37, 0xffff0000, v113
    v_fmac_f32 v30, v36, v25
    v_fmac_f32 v31, v37, v25
    v_lshlrev_b32 v36, 16, v114
    v_and_b32 v37, 0xffff0000, v114
    v_fmac_f32 v32, v36, v25
    v_fmac_f32 v33, v37, v25
    v_lshlrev_b32 v36, 16, v115
    v_and_b32 v37, 0xffff0000, v115
    v_fmac_f32 v34, v36, v25
    v_fmac_f32 v35, v37, v25
    v_lshlrev_b32 v36, 16, v116
    v_and_b32 v37, 0xffff0000, v116
    v_fmac_f32 v28, v36, v26
    v_fmac_f32 v29, v37, v26
    v_lshlrev_b32 v36, 16, v117
    v_and_b32 v37, 0xffff0000, v117
    v_fmac_f32 v30, v36, v26
    v_fmac_f32 v31, v37, v26
    v_lshlrev_b32 v36, 16, v118
    v_and_b32 v37, 0xffff0000, v118
    v_fmac_f32 v32, v36, v26
    v_fmac_f32 v33, v37, v26
    v_lshlrev_b32 v36, 16, v119
    v_and_b32 v37, 0xffff0000, v119
    v_fmac_f32 v34, v36, v26
    v_fmac_f32 v35, v37, v26
    v_lshlrev_b32 v36, 16, v120
    v_and_b32 v37, 0xffff0000, v120
    v_fmac_f32 v28, v36, v27
    v_fmac_f32 v29, v37, v27
    v_lshlrev_b32 v36, 16, v121
    v_and_b32 v37, 0xffff0000, v121
    v_fmac_f32 v30, v36, v27
    v_fmac_f32 v31, v37, v27
    v_lshlrev_b32 v36, 16, v122
    v_and_b32 v37, 0xffff0000, v122
    v_fmac_f32 v32, v36, v27
    v_fmac_f32 v33, v37, v27
    v_lshlrev_b32 v36, 16, v123
    v_and_b32 v37, 0xffff0000, v123
    v_fmac_f32 v34, v36, v27
    v_fmac_f32 v35, v37, v27
    v_lshlrev_b32 v4, 9, v1
    v_lshl_add_u32 v4, v2, 5, v4
    ds_write_b128 v4, v[28:31] offset:1024
    ds_write_b128 v4, v[32:35] offset:1040
    s_waitcnt lgkmcnt(0)
    s_barrier
    v_cmp_gt_u32 vcc, 128, v0
    s_and_saveexec_b64 s[58:59], vcc
    s_cbranch_execz k3_kernel_end
    v_lshlrev_b32 v4, 2, v0
    ds_read_b32 v8, v4 offset:1024
    ds_read_b32 v9, v4 offset:1536
    ds_read_b32 v10, v4 offset:2048
    ds_read_b32 v11, v4 offset:2560
    ds_read_b32 v12, v4 offset:3072
    ds_read_b32 v13, v4 offset:3584
    ds_read_b32 v14, v4 offset:4096
    ds_read_b32 v15, v4 offset:4608
    ds_read_b32 v16, v4 offset:5120
    ds_read_b32 v17, v4 offset:5632
    ds_read_b32 v18, v4 offset:6144
    ds_read_b32 v19, v4 offset:6656
    ds_read_b32 v20, v4 offset:7168
    ds_read_b32 v21, v4 offset:7680
    ds_read_b32 v22, v4 offset:8192
    ds_read_b32 v23, v4 offset:8704
    s_waitcnt lgkmcnt(0)
    v_add_f32 v8, v8, v16
    v_add_f32 v9, v9, v17
    v_add_f32 v10, v10, v18
    v_add_f32 v11, v11, v19
    v_add_f32 v12, v12, v20
    v_add_f32 v13, v13, v21
    v_add_f32 v14, v14, v22
    v_add_f32 v15, v15, v23
    v_add_f32 v8, v8, v12
    v_add_f32 v9, v9, v13
    v_add_f32 v10, v10, v14
    v_add_f32 v11, v11, v15
    v_add_f32 v8, v8, v10
    v_add_f32 v9, v9, v11
    v_add_f32 v8, v8, v9
    v_add_u32 v4, s55, v4
    buffer_store_dword v8, v4, s[48:51], 0 offen
    s_branch k3_kernel_end
k3_att:
    s_mov_b32 s44, s18
    s_mov_b32 s45, s19
    s_mov_b32 s46, 8388608
    s_mov_b32 s47, 0x00020000
    v_lshrrev_b32 v1, 6, v0
    v_and_b32 v2, 63, v0
    s_nop 0
    v_readfirstlane_b32 s60, v1
    s_mul_i32 s61, s2, 65536
    s_lshl_b32 s62, s60, 14
    s_add_u32 s61, s61, s62
    v_lshlrev_b32 v3, 4, v2
    s_mul_i32 s63, s60, 16640
    s_add_u32 s63, s63, 41472
    s_add_u32 s64, s63, 0
    s_mov_b32 m0, s64
    s_add_u32 s65, s61, 0
    buffer_load_dwordx4 v3, s[44:47], s65 offen lds
    s_add_u32 s64, s63, 1040
    s_mov_b32 m0, s64
    s_add_u32 s65, s61, 1024
    buffer_load_dwordx4 v3, s[44:47], s65 offen lds
    s_add_u32 s64, s63, 2080
    s_mov_b32 m0, s64
    s_add_u32 s65, s61, 2048
    buffer_load_dwordx4 v3, s[44:47], s65 offen lds
    s_add_u32 s64, s63, 3120
    s_mov_b32 m0, s64
    s_add_u32 s65, s61, 3072
    buffer_load_dwordx4 v3, s[44:47], s65 offen lds
    s_add_u32 s64, s63, 4160
    s_mov_b32 m0, s64
    s_add_u32 s65, s61, 4096
    buffer_load_dwordx4 v3, s[44:47], s65 offen lds
    s_add_u32 s64, s63, 5200
    s_mov_b32 m0, s64
    s_add_u32 s65, s61, 5120
    buffer_load_dwordx4 v3, s[44:47], s65 offen lds
    s_add_u32 s64, s63, 6240
    s_mov_b32 m0, s64
    s_add_u32 s65, s61, 6144
    buffer_load_dwordx4 v3, s[44:47], s65 offen lds
    s_add_u32 s64, s63, 7280
    s_mov_b32 m0, s64
    s_add_u32 s65, s61, 7168
    buffer_load_dwordx4 v3, s[44:47], s65 offen lds
    s_add_u32 s64, s63, 8320
    s_mov_b32 m0, s64
    s_add_u32 s65, s61, 8192
    buffer_load_dwordx4 v3, s[44:47], s65 offen lds
    s_add_u32 s64, s63, 9360
    s_mov_b32 m0, s64
    s_add_u32 s65, s61, 9216
    buffer_load_dwordx4 v3, s[44:47], s65 offen lds
    s_add_u32 s64, s63, 10400
    s_mov_b32 m0, s64
    s_add_u32 s65, s61, 10240
    buffer_load_dwordx4 v3, s[44:47], s65 offen lds
    s_add_u32 s64, s63, 11440
    s_mov_b32 m0, s64
    s_add_u32 s65, s61, 11264
    buffer_load_dwordx4 v3, s[44:47], s65 offen lds
    s_add_u32 s64, s63, 12480
    s_mov_b32 m0, s64
    s_add_u32 s65, s61, 12288
    buffer_load_dwordx4 v3, s[44:47], s65 offen lds
    s_add_u32 s64, s63, 13520
    s_mov_b32 m0, s64
    s_add_u32 s65, s61, 13312
    buffer_load_dwordx4 v3, s[44:47], s65 offen lds
    s_add_u32 s64, s63, 14560
    s_mov_b32 m0, s64
    s_add_u32 s65, s61, 14336
    buffer_load_dwordx4 v3, s[44:47], s65 offen lds
    s_add_u32 s64, s63, 15600
    s_mov_b32 m0, s64
    s_add_u32 s65, s61, 15360
    buffer_load_dwordx4 v3, s[44:47], s65 offen lds
    s_mul_i32 s63, s60, 8320
    s_add_u32 s63, s63, 8192
    s_lshl_b32 s61, s60, 13
    s_add_u32 s61, s61, 524288
    s_add_u32 s64, s63, 0
    s_mov_b32 m0, s64
    s_add_u32 s65, s61, 0
    buffer_load_dwordx4 v3, s[48:51], s65 offen lds
    s_add_u32 s64, s63, 1040
    s_mov_b32 m0, s64
    s_add_u32 s65, s61, 1024
    buffer_load_dwordx4 v3, s[48:51], s65 offen lds
    s_add_u32 s64, s63, 2080
    s_mov_b32 m0, s64
    s_add_u32 s65, s61, 2048
    buffer_load_dwordx4 v3, s[48:51], s65 offen lds
    s_add_u32 s64, s63, 3120
    s_mov_b32 m0, s64
    s_add_u32 s65, s61, 3072
    buffer_load_dwordx4 v3, s[48:51], s65 offen lds
    s_add_u32 s64, s63, 4160
    s_mov_b32 m0, s64
    s_add_u32 s65, s61, 4096
    buffer_load_dwordx4 v3, s[48:51], s65 offen lds
    s_add_u32 s64, s63, 5200
    s_mov_b32 m0, s64
    s_add_u32 s65, s61, 5120
    buffer_load_dwordx4 v3, s[48:51], s65 offen lds
    s_add_u32 s64, s63, 6240
    s_mov_b32 m0, s64
    s_add_u32 s65, s61, 6144
    buffer_load_dwordx4 v3, s[48:51], s65 offen lds
    s_add_u32 s64, s63, 7280
    s_mov_b32 m0, s64
    s_add_u32 s65, s61, 7168
    buffer_load_dwordx4 v3, s[48:51], s65 offen lds
    v_and_b32 v4, 15, v2
    v_lshrrev_b32 v5, 4, v2
    v_lshlrev_b32 v6, 4, v1
    v_add_u32 v6, v6, v4
    v_mul_u32_u24 v6, 1040, v6
    v_lshl_add_u32 v6, v5, 4, v6
    v_add_u32 v6, 41472, v6
    v_mul_u32_u24 v7, 1040, v4
    v_lshl_add_u32 v7, v5, 4, v7
    v_add_u32 v7, 8192, v7
    v_mov_b32 v16, 0
    v_mov_b32 v17, 0
    v_mov_b32 v18, 0
    v_mov_b32 v19, 0
    v_mov_b32 v20, 0
    v_mov_b32 v21, 0
    v_mov_b32 v22, 0
    v_mov_b32 v23, 0
    s_waitcnt vmcnt(0)
    s_barrier
    ds_read_b128 v[32:35], v6 offset:0
    ds_read_b128 v[36:39], v7 offset:0
    ds_read_b128 v[40:43], v7 offset:16640
    s_waitcnt lgkmcnt(0)
    v_mfma_f32_16x16x32_bf16 v[16:19], v[32:35], v[36:39], v[16:19]
    v_mfma_f32_16x16x32_bf16 v[20:23], v[32:35], v[40:43], v[20:23]
    ds_read_b128 v[44:47], v6 offset:64
    ds_read_b128 v[48:51], v7 offset:64
    ds_read_b128 v[52:55], v7 offset:16704
    s_waitcnt lgkmcnt(0)
    v_mfma_f32_16x16x32_bf16 v[16:19], v[44:47], v[48:51], v[16:19]
    v_mfma_f32_16x16x32_bf16 v[20:23], v[44:47], v[52:55], v[20:23]
    ds_read_b128 v[32:35], v6 offset:128
    ds_read_b128 v[36:39], v7 offset:128
    ds_read_b128 v[40:43], v7 offset:16768
    s_waitcnt lgkmcnt(0)
    v_mfma_f32_16x16x32_bf16 v[16:19], v[32:35], v[36:39], v[16:19]
    v_mfma_f32_16x16x32_bf16 v[20:23], v[32:35], v[40:43], v[20:23]
    ds_read_b128 v[44:47], v6 offset:192
    ds_read_b128 v[48:51], v7 offset:192
    ds_read_b128 v[52:55], v7 offset:16832
    s_waitcnt lgkmcnt(0)
    v_mfma_f32_16x16x32_bf16 v[16:19], v[44:47], v[48:51], v[16:19]
    v_mfma_f32_16x16x32_bf16 v[20:23], v[44:47], v[52:55], v[20:23]
    ds_read_b128 v[32:35], v6 offset:256
    ds_read_b128 v[36:39], v7 offset:256
    ds_read_b128 v[40:43], v7 offset:16896
    s_waitcnt lgkmcnt(0)
    v_mfma_f32_16x16x32_bf16 v[16:19], v[32:35], v[36:39], v[16:19]
    v_mfma_f32_16x16x32_bf16 v[20:23], v[32:35], v[40:43], v[20:23]
    ds_read_b128 v[44:47], v6 offset:320
    ds_read_b128 v[48:51], v7 offset:320
    ds_read_b128 v[52:55], v7 offset:16960
    s_waitcnt lgkmcnt(0)
    v_mfma_f32_16x16x32_bf16 v[16:19], v[44:47], v[48:51], v[16:19]
    v_mfma_f32_16x16x32_bf16 v[20:23], v[44:47], v[52:55], v[20:23]
    ds_read_b128 v[32:35], v6 offset:384
    ds_read_b128 v[36:39], v7 offset:384
    ds_read_b128 v[40:43], v7 offset:17024
    s_waitcnt lgkmcnt(0)
    v_mfma_f32_16x16x32_bf16 v[16:19], v[32:35], v[36:39], v[16:19]
    v_mfma_f32_16x16x32_bf16 v[20:23], v[32:35], v[40:43], v[20:23]
    ds_read_b128 v[44:47], v6 offset:448
    ds_read_b128 v[48:51], v7 offset:448
    ds_read_b128 v[52:55], v7 offset:17088
    s_waitcnt lgkmcnt(0)
    v_mfma_f32_16x16x32_bf16 v[16:19], v[44:47], v[48:51], v[16:19]
    v_mfma_f32_16x16x32_bf16 v[20:23], v[44:47], v[52:55], v[20:23]
    ds_read_b128 v[32:35], v6 offset:512
    ds_read_b128 v[36:39], v7 offset:512
    ds_read_b128 v[40:43], v7 offset:17152
    s_waitcnt lgkmcnt(0)
    v_mfma_f32_16x16x32_bf16 v[16:19], v[32:35], v[36:39], v[16:19]
    v_mfma_f32_16x16x32_bf16 v[20:23], v[32:35], v[40:43], v[20:23]
    ds_read_b128 v[44:47], v6 offset:576
    ds_read_b128 v[48:51], v7 offset:576
    ds_read_b128 v[52:55], v7 offset:17216
    s_waitcnt lgkmcnt(0)
    v_mfma_f32_16x16x32_bf16 v[16:19], v[44:47], v[48:51], v[16:19]
    v_mfma_f32_16x16x32_bf16 v[20:23], v[44:47], v[52:55], v[20:23]
    ds_read_b128 v[32:35], v6 offset:640
    ds_read_b128 v[36:39], v7 offset:640
    ds_read_b128 v[40:43], v7 offset:17280
    s_waitcnt lgkmcnt(0)
    v_mfma_f32_16x16x32_bf16 v[16:19], v[32:35], v[36:39], v[16:19]
    v_mfma_f32_16x16x32_bf16 v[20:23], v[32:35], v[40:43], v[20:23]
    ds_read_b128 v[44:47], v6 offset:704
    ds_read_b128 v[48:51], v7 offset:704
    ds_read_b128 v[52:55], v7 offset:17344
    s_waitcnt lgkmcnt(0)
    v_mfma_f32_16x16x32_bf16 v[16:19], v[44:47], v[48:51], v[16:19]
    v_mfma_f32_16x16x32_bf16 v[20:23], v[44:47], v[52:55], v[20:23]
    ds_read_b128 v[32:35], v6 offset:768
    ds_read_b128 v[36:39], v7 offset:768
    ds_read_b128 v[40:43], v7 offset:17408
    s_waitcnt lgkmcnt(0)
    v_mfma_f32_16x16x32_bf16 v[16:19], v[32:35], v[36:39], v[16:19]
    v_mfma_f32_16x16x32_bf16 v[20:23], v[32:35], v[40:43], v[20:23]
    ds_read_b128 v[44:47], v6 offset:832
    ds_read_b128 v[48:51], v7 offset:832
    ds_read_b128 v[52:55], v7 offset:17472
    s_waitcnt lgkmcnt(0)
    v_mfma_f32_16x16x32_bf16 v[16:19], v[44:47], v[48:51], v[16:19]
    v_mfma_f32_16x16x32_bf16 v[20:23], v[44:47], v[52:55], v[20:23]
    ds_read_b128 v[32:35], v6 offset:896
    ds_read_b128 v[36:39], v7 offset:896
    ds_read_b128 v[40:43], v7 offset:17536
    s_waitcnt lgkmcnt(0)
    v_mfma_f32_16x16x32_bf16 v[16:19], v[32:35], v[36:39], v[16:19]
    v_mfma_f32_16x16x32_bf16 v[20:23], v[32:35], v[40:43], v[20:23]
    ds_read_b128 v[44:47], v6 offset:960
    ds_read_b128 v[48:51], v7 offset:960
    ds_read_b128 v[52:55], v7 offset:17600
    s_waitcnt lgkmcnt(0)
    v_mfma_f32_16x16x32_bf16 v[16:19], v[44:47], v[48:51], v[16:19]
    v_mfma_f32_16x16x32_bf16 v[20:23], v[44:47], v[52:55], v[20:23]
    s_nop 15
    v_max_f32 v24, v16, v17
    v_max3_f32 v24, v24, v18, v19
    v_max_f32 v25, v20, v21
    v_max3_f32 v25, v25, v22, v23
    v_xor_b32 v26, 16, v2
    v_lshlrev_b32 v26, 2, v26
    ds_bpermute_b32 v27, v26, v24
    ds_bpermute_b32 v28, v26, v25
    s_waitcnt lgkmcnt(0)
    v_max_f32 v24, v24, v27
    v_max_f32 v25, v25, v28
    v_xor_b32 v26, 32, v2
    v_lshlrev_b32 v26, 2, v26
    ds_bpermute_b32 v27, v26, v24
    ds_bpermute_b32 v28, v26, v25
    s_waitcnt lgkmcnt(0)
    v_max_f32 v24, v24, v27
    v_max_f32 v25, v25, v28
    v_lshlrev_b32 v26, 7, v1
    v_lshl_add_u32 v26, v4, 2, v26
    ds_write_b32 v26, v24 offset:0
    ds_write_b32 v26, v25 offset:64
    s_waitcnt lgkmcnt(0)
    s_barrier
    v_lshlrev_b32 v26, 2, v4
    ds_read_b32 v40, v26 offset:0
    ds_read_b32 v44, v26 offset:64
    ds_read_b32 v41, v26 offset:128
    ds_read_b32 v45, v26 offset:192
    ds_read_b32 v42, v26 offset:256
    ds_read_b32 v46, v26 offset:320
    ds_read_b32 v43, v26 offset:384
    ds_read_b32 v47, v26 offset:448
    s_waitcnt lgkmcnt(0)
    v_max_f32 v24, v40, v41
    v_max3_f32 v24, v24, v42, v43
    v_max_f32 v25, v44, v45
    v_max3_f32 v25, v25, v46, v47
    s_mov_b32 s66, 0x3e0293ee
    v_sub_f32 v16, v16, v24
    v_sub_f32 v20, v20, v25
    v_sub_f32 v17, v17, v24
    v_sub_f32 v21, v21, v25
    v_sub_f32 v18, v18, v24
    v_sub_f32 v22, v22, v25
    v_sub_f32 v19, v19, v24
    v_sub_f32 v23, v23, v25
    v_mul_f32 v16, s66, v16
    v_mul_f32 v17, s66, v17
    v_mul_f32 v18, s66, v18
    v_mul_f32 v19, s66, v19
    v_mul_f32 v20, s66, v20
    v_mul_f32 v21, s66, v21
    v_mul_f32 v22, s66, v22
    v_mul_f32 v23, s66, v23
    v_exp_f32 v16, v16
    v_exp_f32 v17, v17
    v_exp_f32 v18, v18
    v_exp_f32 v19, v19
    v_exp_f32 v20, v20
    v_exp_f32 v21, v21
    v_exp_f32 v22, v22
    v_exp_f32 v23, v23
    s_nop 1
    v_add_f32 v27, v16, v17
    v_add_f32 v28, v18, v19
    v_add_f32 v27, v27, v28
    v_add_f32 v28, v20, v21
    v_add_f32 v29, v22, v23
    v_add_f32 v28, v28, v29
    v_cvt_pk_bf16_f32 v32, v16, v17
    v_cvt_pk_bf16_f32 v33, v18, v19
    v_cvt_pk_bf16_f32 v34, v20, v21
    v_cvt_pk_bf16_f32 v35, v22, v23
    v_mul_u32_u24 v36, 144, v4
    v_lshlrev_b32 v37, 5, v1
    v_add_u32 v36, v36, v37
    v_lshl_add_u32 v36, v5, 3, v36
    ds_write_b64 v36, v[32:33] offset:2048
    ds_write_b64 v36, v[34:35] offset:4352
    v_xor_b32 v26, 16, v2
    v_lshlrev_b32 v26, 2, v26
    ds_bpermute_b32 v29, v26, v27
    ds_bpermute_b32 v30, v26, v28
    s_waitcnt lgkmcnt(0)
    v_add_f32 v27, v27, v29
    v_add_f32 v28, v28, v30
    v_xor_b32 v26, 32, v2
    v_lshlrev_b32 v26, 2, v26
    ds_bpermute_b32 v29, v26, v27
    ds_bpermute_b32 v30, v26, v28
    s_waitcnt lgkmcnt(0)
    v_add_f32 v27, v27, v29
    v_add_f32 v28, v28, v30
    v_lshlrev_b32 v26, 7, v1
    v_lshl_add_u32 v26, v4, 2, v26
    ds_write_b32 v26, v27 offset:512
    ds_write_b32 v26, v28 offset:576
    s_waitcnt lgkmcnt(0)
    s_barrier
    v_lshlrev_b32 v26, 2, v4
    ds_read_b32 v40, v26 offset:512
    ds_read_b32 v44, v26 offset:576
    ds_read_b32 v41, v26 offset:640
    ds_read_b32 v45, v26 offset:704
    ds_read_b32 v42, v26 offset:768
    ds_read_b32 v46, v26 offset:832
    ds_read_b32 v43, v26 offset:896
    ds_read_b32 v47, v26 offset:960
    s_waitcnt lgkmcnt(0)
    v_add_f32 v40, v40, v41
    v_add_f32 v42, v42, v43
    v_add_f32 v40, v40, v42
    v_add_f32 v44, v44, v45
    v_add_f32 v46, v46, v47
    v_add_f32 v44, v44, v46
    s_lshl_b32 s61, s2, 8
    s_add_u32 s61, s61, 786432
    v_lshl_add_u32 v26, v4, 3, s61
    v_cmp_gt_u32 vcc, 16, v0
    s_and_saveexec_b64 s[58:59], vcc
    v_mov_b32 v41, v40
    v_mov_b32 v40, v24
    v_mov_b32 v45, v44
    v_mov_b32 v44, v25
    buffer_store_dwordx2 v[40:41], v26, s[48:51], 0 offen
    buffer_store_dwordx2 v[44:45], v26, s[48:51], 0 offen offset:128
    s_mov_b64 exec, s[58:59]
    v_and_b32 v4, 31, v2
    v_lshrrev_b32 v5, 5, v2
    v_mul_u32_u24 v6, 144, v4
    v_lshl_add_u32 v6, v5, 4, v6
    v_add_u32 v6, 2048, v6
    v_and_b32 v7, 15, v2
    v_lshrrev_b32 v8, 2, v7
    v_lshl_add_u32 v8, v5, 3, v8
    v_mul_u32_u24 v8, 1040, v8
    v_and_b32 v9, 3, v7
    v_lshlrev_b32 v9, 3, v9
    v_bfe_u32 v10, v2, 4, 1
    v_lshl_add_u32 v9, v10, 5, v9
    v_add_u32 v8, v8, v9
    v_lshl_add_u32 v8, v1, 8, v8
    v_add_u32 v8, 41472, v8
    v_mov_b32 v64, 0
    v_mov_b32 v65, 0
    v_mov_b32 v66, 0
    v_mov_b32 v67, 0
    v_mov_b32 v68, 0
    v_mov_b32 v69, 0
    v_mov_b32 v70, 0
    v_mov_b32 v71, 0
    v_mov_b32 v72, 0
    v_mov_b32 v73, 0
    v_mov_b32 v74, 0
    v_mov_b32 v75, 0
    v_mov_b32 v76, 0
    v_mov_b32 v77, 0
    v_mov_b32 v78, 0
    v_mov_b32 v79, 0
    v_mov_b32 v80, 0
    v_mov_b32 v81, 0
    v_mov_b32 v82, 0
    v_mov_b32 v83, 0
    v_mov_b32 v84, 0
    v_mov_b32 v85, 0
    v_mov_b32 v86, 0
    v_mov_b32 v87, 0
    v_mov_b32 v88, 0
    v_mov_b32 v89, 0
    v_mov_b32 v90, 0
    v_mov_b32 v91, 0
    v_mov_b32 v92, 0
    v_mov_b32 v93, 0
    v_mov_b32 v94, 0
    v_mov_b32 v95, 0
    v_mov_b32 v96, 0
    v_mov_b32 v97, 0
    v_mov_b32 v98, 0
    v_mov_b32 v99, 0
    v_mov_b32 v100, 0
    v_mov_b32 v101, 0
    v_mov_b32 v102, 0
    v_mov_b32 v103, 0
    v_mov_b32 v104, 0
    v_mov_b32 v105, 0
    v_mov_b32 v106, 0
    v_mov_b32 v107, 0
    v_mov_b32 v108, 0
    v_mov_b32 v109, 0
    v_mov_b32 v110, 0
    v_mov_b32 v111, 0
    v_mov_b32 v112, 0
    v_mov_b32 v113, 0
    v_mov_b32 v114, 0
    v_mov_b32 v115, 0
    v_mov_b32 v116, 0
    v_mov_b32 v117, 0
    v_mov_b32 v118, 0
    v_mov_b32 v119, 0
    v_mov_b32 v120, 0
    v_mov_b32 v121, 0
    v_mov_b32 v122, 0
    v_mov_b32 v123, 0
    v_mov_b32 v124, 0
    v_mov_b32 v125, 0
    v_mov_b32 v126, 0
    v_mov_b32 v127, 0
    ds_read_b128 v[12:15], v6 offset:0
    ds_read_b64_tr_b16 v[16:17], v8 offset:0
    ds_read_b64_tr_b16 v[18:19], v8 offset:4160
    ds_read_b64_tr_b16 v[20:21], v8 offset:64
    ds_read_b64_tr_b16 v[22:23], v8 offset:4224
    ds_read_b64_tr_b16 v[24:25], v8 offset:128
    ds_read_b64_tr_b16 v[26:27], v8 offset:4288
    ds_read_b64_tr_b16 v[28:29], v8 offset:192
    ds_read_b64_tr_b16 v[30:31], v8 offset:4352
    s_waitcnt lgkmcnt(0)
    v_mfma_f32_32x32x16_bf16 v[64:79], v[12:15], v[16:19], v[64:79]
    v_mfma_f32_32x32x16_bf16 v[80:95], v[12:15], v[20:23], v[80:95]
    v_mfma_f32_32x32x16_bf16 v[96:111], v[12:15], v[24:27], v[96:111]
    v_mfma_f32_32x32x16_bf16 v[112:127], v[12:15], v[28:31], v[112:127]
    ds_read_b128 v[12:15], v6 offset:32
    ds_read_b64_tr_b16 v[16:17], v8 offset:16640
    ds_read_b64_tr_b16 v[18:19], v8 offset:20800
    ds_read_b64_tr_b16 v[20:21], v8 offset:16704
    ds_read_b64_tr_b16 v[22:23], v8 offset:20864
    ds_read_b64_tr_b16 v[24:25], v8 offset:16768
    ds_read_b64_tr_b16 v[26:27], v8 offset:20928
    ds_read_b64_tr_b16 v[28:29], v8 offset:16832
    ds_read_b64_tr_b16 v[30:31], v8 offset:20992
    s_waitcnt lgkmcnt(0)
    v_mfma_f32_32x32x16_bf16 v[64:79], v[12:15], v[16:19], v[64:79]
    v_mfma_f32_32x32x16_bf16 v[80:95], v[12:15], v[20:23], v[80:95]
    v_mfma_f32_32x32x16_bf16 v[96:111], v[12:15], v[24:27], v[96:111]
    v_mfma_f32_32x32x16_bf16 v[112:127], v[12:15], v[28:31], v[112:127]
    ds_read_b128 v[12:15], v6 offset:64
    ds_read_b64_tr_b16 v[16:17], v8 offset:33280
    ds_read_b64_tr_b16 v[18:19], v8 offset:37440
    ds_read_b64_tr_b16 v[20:21], v8 offset:33344
    ds_read_b64_tr_b16 v[22:23], v8 offset:37504
    ds_read_b64_tr_b16 v[24:25], v8 offset:33408
    ds_read_b64_tr_b16 v[26:27], v8 offset:37568
    ds_read_b64_tr_b16 v[28:29], v8 offset:33472
    ds_read_b64_tr_b16 v[30:31], v8 offset:37632
    s_waitcnt lgkmcnt(0)
    v_mfma_f32_32x32x16_bf16 v[64:79], v[12:15], v[16:19], v[64:79]
    v_mfma_f32_32x32x16_bf16 v[80:95], v[12:15], v[20:23], v[80:95]
    v_mfma_f32_32x32x16_bf16 v[96:111], v[12:15], v[24:27], v[96:111]
    v_mfma_f32_32x32x16_bf16 v[112:127], v[12:15], v[28:31], v[112:127]
    ds_read_b128 v[12:15], v6 offset:96
    ds_read_b64_tr_b16 v[16:17], v8 offset:49920
    ds_read_b64_tr_b16 v[18:19], v8 offset:54080
    ds_read_b64_tr_b16 v[20:21], v8 offset:49984
    ds_read_b64_tr_b16 v[22:23], v8 offset:54144
    ds_read_b64_tr_b16 v[24:25], v8 offset:50048
    ds_read_b64_tr_b16 v[26:27], v8 offset:54208
    ds_read_b64_tr_b16 v[28:29], v8 offset:50112
    ds_read_b64_tr_b16 v[30:31], v8 offset:54272
    s_waitcnt lgkmcnt(0)
    v_mfma_f32_32x32x16_bf16 v[64:79], v[12:15], v[16:19], v[64:79]
    v_mfma_f32_32x32x16_bf16 v[80:95], v[12:15], v[20:23], v[80:95]
    v_mfma_f32_32x32x16_bf16 v[96:111], v[12:15], v[24:27], v[96:111]
    v_mfma_f32_32x32x16_bf16 v[112:127], v[12:15], v[28:31], v[112:127]
    s_nop 15
    s_nop 3
    s_lshl_b32 s61, s2, 16
    s_add_u32 s61, s61, 2097152
    v_lshlrev_b32 v9, 13, v5
    v_lshl_add_u32 v9, v4, 2, v9
    v_lshl_add_u32 v9, v1, 9, v9
    v_add_u32 v9, s61, v9
    buffer_store_dword v64, v9, s[48:51], 0 offen offset:0
    buffer_store_dword v65, v9, s[48:51], 0 offen offset:2048
    v_add_u32 v10, 4096, v9
    buffer_store_dword v66, v10, s[48:51], 0 offen
    v_add_u32 v10, 6144, v9
    buffer_store_dword v67, v10, s[48:51], 0 offen
    v_add_u32 v10, 16384, v9
    buffer_store_dword v68, v10, s[48:51], 0 offen
    v_add_u32 v10, 18432, v9
    buffer_store_dword v69, v10, s[48:51], 0 offen
    v_add_u32 v10, 20480, v9
    buffer_store_dword v70, v10, s[48:51], 0 offen
    v_add_u32 v10, 22528, v9
    buffer_store_dword v71, v10, s[48:51], 0 offen
    v_add_u32 v10, 32768, v9
    buffer_store_dword v72, v10, s[48:51], 0 offen
    v_add_u32 v10, 34816, v9
    buffer_store_dword v73, v10, s[48:51], 0 offen
    v_add_u32 v10, 36864, v9
    buffer_store_dword v74, v10, s[48:51], 0 offen
    v_add_u32 v10, 38912, v9
    buffer_store_dword v75, v10, s[48:51], 0 offen
    v_add_u32 v10, 49152, v9
    buffer_store_dword v76, v10, s[48:51], 0 offen
    v_add_u32 v10, 51200, v9
    buffer_store_dword v77, v10, s[48:51], 0 offen
    v_add_u32 v10, 53248, v9
    buffer_store_dword v78, v10, s[48:51], 0 offen
    v_add_u32 v10, 55296, v9
    buffer_store_dword v79, v10, s[48:51], 0 offen
    buffer_store_dword v80, v9, s[48:51], 0 offen offset:128
    buffer_store_dword v81, v9, s[48:51], 0 offen offset:2176
    v_add_u32 v10, 4224, v9
    buffer_store_dword v82, v10, s[48:51], 0 offen
    v_add_u32 v10, 6272, v9
    buffer_store_dword v83, v10, s[48:51], 0 offen
    v_add_u32 v10, 16512, v9
    buffer_store_dword v84, v10, s[48:51], 0 offen
    v_add_u32 v10, 18560, v9
    buffer_store_dword v85, v10, s[48:51], 0 offen
    v_add_u32 v10, 20608, v9
    buffer_store_dword v86, v10, s[48:51], 0 offen
    v_add_u32 v10, 22656, v9
    buffer_store_dword v87, v10, s[48:51], 0 offen
    v_add_u32 v10, 32896, v9
    buffer_store_dword v88, v10, s[48:51], 0 offen
    v_add_u32 v10, 34944, v9
    buffer_store_dword v89, v10, s[48:51], 0 offen
    v_add_u32 v10, 36992, v9
    buffer_store_dword v90, v10, s[48:51], 0 offen
    v_add_u32 v10, 39040, v9
    buffer_store_dword v91, v10, s[48:51], 0 offen
    v_add_u32 v10, 49280, v9
    buffer_store_dword v92, v10, s[48:51], 0 offen
    v_add_u32 v10, 51328, v9
    buffer_store_dword v93, v10, s[48:51], 0 offen
    v_add_u32 v10, 53376, v9
    buffer_store_dword v94, v10, s[48:51], 0 offen
    v_add_u32 v10, 55424, v9
    buffer_store_dword v95, v10, s[48:51], 0 offen
    buffer_store_dword v96, v9, s[48:51], 0 offen offset:256
    buffer_store_dword v97, v9, s[48:51], 0 offen offset:2304
    v_add_u32 v10, 4352, v9
    buffer_store_dword v98, v10, s[48:51], 0 offen
    v_add_u32 v10, 6400, v9
    buffer_store_dword v99, v10, s[48:51], 0 offen
    v_add_u32 v10, 16640, v9
    buffer_store_dword v100, v10, s[48:51], 0 offen
    v_add_u32 v10, 18688, v9
    buffer_store_dword v101, v10, s[48:51], 0 offen
    v_add_u32 v10, 20736, v9
    buffer_store_dword v102, v10, s[48:51], 0 offen
    v_add_u32 v10, 22784, v9
    buffer_store_dword v103, v10, s[48:51], 0 offen
    v_add_u32 v10, 33024, v9
    buffer_store_dword v104, v10, s[48:51], 0 offen
    v_add_u32 v10, 35072, v9
    buffer_store_dword v105, v10, s[48:51], 0 offen
    v_add_u32 v10, 37120, v9
    buffer_store_dword v106, v10, s[48:51], 0 offen
    v_add_u32 v10, 39168, v9
    buffer_store_dword v107, v10, s[48:51], 0 offen
    v_add_u32 v10, 49408, v9
    buffer_store_dword v108, v10, s[48:51], 0 offen
    v_add_u32 v10, 51456, v9
    buffer_store_dword v109, v10, s[48:51], 0 offen
    v_add_u32 v10, 53504, v9
    buffer_store_dword v110, v10, s[48:51], 0 offen
    v_add_u32 v10, 55552, v9
    buffer_store_dword v111, v10, s[48:51], 0 offen
    buffer_store_dword v112, v9, s[48:51], 0 offen offset:384
    buffer_store_dword v113, v9, s[48:51], 0 offen offset:2432
    v_add_u32 v10, 4480, v9
    buffer_store_dword v114, v10, s[48:51], 0 offen
    v_add_u32 v10, 6528, v9
    buffer_store_dword v115, v10, s[48:51], 0 offen
    v_add_u32 v10, 16768, v9
    buffer_store_dword v116, v10, s[48:51], 0 offen
    v_add_u32 v10, 18816, v9
    buffer_store_dword v117, v10, s[48:51], 0 offen
    v_add_u32 v10, 20864, v9
    buffer_store_dword v118, v10, s[48:51], 0 offen
    v_add_u32 v10, 22912, v9
    buffer_store_dword v119, v10, s[48:51], 0 offen
    v_add_u32 v10, 33152, v9
    buffer_store_dword v120, v10, s[48:51], 0 offen
    v_add_u32 v10, 35200, v9
    buffer_store_dword v121, v10, s[48:51], 0 offen
    v_add_u32 v10, 37248, v9
    buffer_store_dword v122, v10, s[48:51], 0 offen
    v_add_u32 v10, 39296, v9
    buffer_store_dword v123, v10, s[48:51], 0 offen
    v_add_u32 v10, 49536, v9
    buffer_store_dword v124, v10, s[48:51], 0 offen
    v_add_u32 v10, 51584, v9
    buffer_store_dword v125, v10, s[48:51], 0 offen
    v_add_u32 v10, 53632, v9
    buffer_store_dword v126, v10, s[48:51], 0 offen
    v_add_u32 v10, 55680, v9
    buffer_store_dword v127, v10, s[48:51], 0 offen
    s_waitcnt vmcnt(0)
k3_kernel_end:
    s_endpgm
.globl k4_kernel
.p2align 8
.type k4_kernel,@function
k4_kernel:
    s_cmp_ge_u32 s2, 256
    s_cbranch_scc1 k4_kernel_end
    s_load_dwordx16 s[16:31], s[0:1], 0
    s_load_dwordx8 s[32:39], s[0:1], 64
    s_load_dwordx4 s[40:43], s[0:1], 96
    s_waitcnt lgkmcnt(0)
    s_mov_b32 s48, s42
    s_mov_b32 s49, s43
    s_mov_b32 s50, 16777216
    s_mov_b32 s51, 0x00020000
    s_lshr_b32 s57, s2, 3
    s_and_b32 s60, s2, 7
    s_mov_b32 s44, s24
    s_mov_b32 s45, s25
    s_mov_b32 s46, 4194304
    s_mov_b32 s47, 0x00020000
    s_movk_i32 s52, 8192
    s_lshl_b32 s53, s60, 6
    s_lshl_b32 s54, s57, 8
    s_lshl_b32 s55, s60, 14
    s_lshl_b32 s61, s57, 9
    s_add_u32 s55, s55, s61
    s_add_u32 s55, s55, 917504
    v_lshrrev_b32 v1, 4, v0
    v_and_b32 v2, 15, v0
    v_add_u32 v3, s53, v1
    v_mul_lo_u32 v3, v3, s52
    v_lshl_add_u32 v3, v2, 4, v3
    v_add_u32 v3, s54, v3
    s_lshl_b32 s56, s52, 4
    buffer_load_dwordx4 v[108:111], v3, s[44:47], 0 offen
    v_add_u32 v3, s56, v3
    buffer_load_dwordx4 v[112:115], v3, s[44:47], 0 offen
    v_add_u32 v3, s56, v3
    buffer_load_dwordx4 v[116:119], v3, s[44:47], 0 offen
    v_add_u32 v3, s56, v3
    buffer_load_dwordx4 v[120:123], v3, s[44:47], 0 offen
    v_lshrrev_b32 v1, 6, v0
    v_and_b32 v2, 63, v0
    s_lshl_b32 s61, s57, 3
    s_add_u32 s61, s61, 786432
    v_lshl_add_u32 v3, v2, 8, s61
    buffer_load_dwordx2 v[4:5], v3, s[48:51], 0 offen
    v_add_u32 v3, 16384, v3
    buffer_load_dwordx2 v[6:7], v3, s[48:51], 0 offen
    s_waitcnt vmcnt(0)
    v_max_f32 v8, v4, v6
    s_nop 1
    v_max_f32_dpp v8, v8, v8 row_ror:8 row_mask:0xf bank_mask:0xf
    s_nop 1
    v_max_f32_dpp v8, v8, v8 row_ror:4 row_mask:0xf bank_mask:0xf
    s_nop 1
    v_max_f32_dpp v8, v8, v8 row_ror:2 row_mask:0xf bank_mask:0xf
    s_nop 1
    v_max_f32_dpp v8, v8, v8 row_ror:1 row_mask:0xf bank_mask:0xf
    s_nop 1
    v_readlane_b32 s61, v8, 0
    v_readlane_b32 s62, v8, 16
    v_readlane_b32 s63, v8, 32
    v_readlane_b32 s64, v8, 48
    s_nop 1
    v_mov_b32 v8, s61
    v_max_f32 v8, s62, v8
    v_max_f32 v8, s63, v8
    v_max_f32 v8, s64, v8
    s_mov_b32 s66, 0x3e0293ee
    v_sub_f32 v4, v4, v8
    v_sub_f32 v6, v6, v8
    v_mul_f32 v4, s66, v4
    v_mul_f32 v6, s66, v6
    v_exp_f32 v4, v4
    v_exp_f32 v6, v6
    s_nop 1
    v_mul_f32 v9, v4, v5
    v_fmac_f32 v9, v6, v7
    s_nop 1
    v_add_f32_dpp v9, v9, v9 row_ror:8 row_mask:0xf bank_mask:0xf
    s_nop 1
    v_add_f32_dpp v9, v9, v9 row_ror:4 row_mask:0xf bank_mask:0xf
    s_nop 1
    v_add_f32_dpp v9, v9, v9 row_ror:2 row_mask:0xf bank_mask:0xf
    s_nop 1
    v_add_f32_dpp v9, v9, v9 row_ror:1 row_mask:0xf bank_mask:0xf
    s_nop 1
    v_readlane_b32 s61, v9, 0
    v_readlane_b32 s62, v9, 16
    v_readlane_b32 s63, v9, 32
    v_readlane_b32 s64, v9, 48
    s_nop 1
    v_mov_b32 v9, s61
    v_add_f32 v9, s62, v9
    v_add_f32 v9, s63, v9
    v_add_f32 v9, s64, v9
    v_rcp_f32 v9, v9
    s_nop 1
    v_mul_f32 v4, v4, v9
    v_mul_f32 v6, v6, v9
    v_readfirstlane_b32 s60, v1
    s_and_b32 s61, s2, 7
    s_lshl_b32 s61, s61, 8
    s_lshl_b32 s62, s57, 11
    s_add_u32 s61, s61, s62
    s_add_u32 s61, s61, 2097152
    s_lshl_b32 s62, s60, 21
    s_add_u32 s61, s61, s62
    v_lshl_add_u32 v3, v2, 2, s61
    buffer_load_dword v16, v3, s[48:51], 0 offen
    v_add_u32 v3, 0x10000, v3
    buffer_load_dword v17, v3, s[48:51], 0 offen
    v_add_u32 v3, 0x10000, v3
    buffer_load_dword v18, v3, s[48:51], 0 offen
    v_add_u32 v3, 0x10000, v3
    buffer_load_dword v19, v3, s[48:51], 0 offen
    v_add_u32 v3, 0x10000, v3
    buffer_load_dword v20, v3, s[48:51], 0 offen
    v_add_u32 v3, 0x10000, v3
    buffer_load_dword v21, v3, s[48:51], 0 offen
    v_add_u32 v3, 0x10000, v3
    buffer_load_dword v22, v3, s[48:51], 0 offen
    v_add_u32 v3, 0x10000, v3
    buffer_load_dword v23, v3, s[48:51], 0 offen
    v_add_u32 v3, 0x10000, v3
    buffer_load_dword v24, v3, s[48:51], 0 offen
    v_add_u32 v3, 0x10000, v3
    buffer_load_dword v25, v3, s[48:51], 0 offen
    v_add_u32 v3, 0x10000, v3
    buffer_load_dword v26, v3, s[48:51], 0 offen
    v_add_u32 v3, 0x10000, v3
    buffer_load_dword v27, v3, s[48:51], 0 offen
    v_add_u32 v3, 0x10000, v3
    buffer_load_dword v28, v3, s[48:51], 0 offen
    v_add_u32 v3, 0x10000, v3
    buffer_load_dword v29, v3, s[48:51], 0 offen
    v_add_u32 v3, 0x10000, v3
    buffer_load_dword v30, v3, s[48:51], 0 offen
    v_add_u32 v3, 0x10000, v3
    buffer_load_dword v31, v3, s[48:51], 0 offen
    v_add_u32 v3, 0x10000, v3
    buffer_load_dword v32, v3, s[48:51], 0 offen
    v_add_u32 v3, 0x10000, v3
    buffer_load_dword v33, v3, s[48:51], 0 offen
    v_add_u32 v3, 0x10000, v3
    buffer_load_dword v34, v3, s[48:51], 0 offen
    v_add_u32 v3, 0x10000, v3
    buffer_load_dword v35, v3, s[48:51], 0 offen
    v_add_u32 v3, 0x10000, v3
    buffer_load_dword v36, v3, s[48:51], 0 offen
    v_add_u32 v3, 0x10000, v3
    buffer_load_dword v37, v3, s[48:51], 0 offen
    v_add_u32 v3, 0x10000, v3
    buffer_load_dword v38, v3, s[48:51], 0 offen
    v_add_u32 v3, 0x10000, v3
    buffer_load_dword v39, v3, s[48:51], 0 offen
    v_add_u32 v3, 0x10000, v3
    buffer_load_dword v40, v3, s[48:51], 0 offen
    v_add_u32 v3, 0x10000, v3
    buffer_load_dword v41, v3, s[48:51], 0 offen
    v_add_u32 v3, 0x10000, v3
    buffer_load_dword v42, v3, s[48:51], 0 offen
    v_add_u32 v3, 0x10000, v3
    buffer_load_dword v43, v3, s[48:51], 0 offen
    v_add_u32 v3, 0x10000, v3
    buffer_load_dword v44, v3, s[48:51], 0 offen
    v_add_u32 v3, 0x10000, v3
    buffer_load_dword v45, v3, s[48:51], 0 offen
    v_add_u32 v3, 0x10000, v3
    buffer_load_dword v46, v3, s[48:51], 0 offen
    v_add_u32 v3, 0x10000, v3
    buffer_load_dword v47, v3, s[48:51], 0 offen
    s_lshl_b32 s62, s60, 5
    s_and_b32 s63, s62, 63
    s_cmp_ge_u32 s60, 2
    s_cselect_b64 vcc, -1, 0
    s_nop 1
    v_cndmask_b32 v10, v4, v6, vcc
    v_mov_b32 v11, 0
    s_waitcnt vmcnt(0)
    s_add_u32 s64, s63, 0
    s_nop 0
    v_readlane_b32 s65, v10, s64
    s_nop 1
    v_fmac_f32 v11, s65, v16
    s_add_u32 s64, s63, 1
    s_nop 0
    v_readlane_b32 s65, v10, s64
    s_nop 1
    v_fmac_f32 v11, s65, v17
    s_add_u32 s64, s63, 2
    s_nop 0
    v_readlane_b32 s65, v10, s64
    s_nop 1
    v_fmac_f32 v11, s65, v18
    s_add_u32 s64, s63, 3
    s_nop 0
    v_readlane_b32 s65, v10, s64
    s_nop 1
    v_fmac_f32 v11, s65, v19
    s_add_u32 s64, s63, 4
    s_nop 0
    v_readlane_b32 s65, v10, s64
    s_nop 1
    v_fmac_f32 v11, s65, v20
    s_add_u32 s64, s63, 5
    s_nop 0
    v_readlane_b32 s65, v10, s64
    s_nop 1
    v_fmac_f32 v11, s65, v21
    s_add_u32 s64, s63, 6
    s_nop 0
    v_readlane_b32 s65, v10, s64
    s_nop 1
    v_fmac_f32 v11, s65, v22
    s_add_u32 s64, s63, 7
    s_nop 0
    v_readlane_b32 s65, v10, s64
    s_nop 1
    v_fmac_f32 v11, s65, v23
    s_add_u32 s64, s63, 8
    s_nop 0
    v_readlane_b32 s65, v10, s64
    s_nop 1
    v_fmac_f32 v11, s65, v24
    s_add_u32 s64, s63, 9
    s_nop 0
    v_readlane_b32 s65, v10, s64
    s_nop 1
    v_fmac_f32 v11, s65, v25
    s_add_u32 s64, s63, 10
    s_nop 0
    v_readlane_b32 s65, v10, s64
    s_nop 1
    v_fmac_f32 v11, s65, v26
    s_add_u32 s64, s63, 11
    s_nop 0
    v_readlane_b32 s65, v10, s64
    s_nop 1
    v_fmac_f32 v11, s65, v27
    s_add_u32 s64, s63, 12
    s_nop 0
    v_readlane_b32 s65, v10, s64
    s_nop 1
    v_fmac_f32 v11, s65, v28
    s_add_u32 s64, s63, 13
    s_nop 0
    v_readlane_b32 s65, v10, s64
    s_nop 1
    v_fmac_f32 v11, s65, v29
    s_add_u32 s64, s63, 14
    s_nop 0
    v_readlane_b32 s65, v10, s64
    s_nop 1
    v_fmac_f32 v11, s65, v30
    s_add_u32 s64, s63, 15
    s_nop 0
    v_readlane_b32 s65, v10, s64
    s_nop 1
    v_fmac_f32 v11, s65, v31
    s_add_u32 s64, s63, 16
    s_nop 0
    v_readlane_b32 s65, v10, s64
    s_nop 1
    v_fmac_f32 v11, s65, v32
    s_add_u32 s64, s63, 17
    s_nop 0
    v_readlane_b32 s65, v10, s64
    s_nop 1
    v_fmac_f32 v11, s65, v33
    s_add_u32 s64, s63, 18
    s_nop 0
    v_readlane_b32 s65, v10, s64
    s_nop 1
    v_fmac_f32 v11, s65, v34
    s_add_u32 s64, s63, 19
    s_nop 0
    v_readlane_b32 s65, v10, s64
    s_nop 1
    v_fmac_f32 v11, s65, v35
    s_add_u32 s64, s63, 20
    s_nop 0
    v_readlane_b32 s65, v10, s64
    s_nop 1
    v_fmac_f32 v11, s65, v36
    s_add_u32 s64, s63, 21
    s_nop 0
    v_readlane_b32 s65, v10, s64
    s_nop 1
    v_fmac_f32 v11, s65, v37
    s_add_u32 s64, s63, 22
    s_nop 0
    v_readlane_b32 s65, v10, s64
    s_nop 1
    v_fmac_f32 v11, s65, v38
    s_add_u32 s64, s63, 23
    s_nop 0
    v_readlane_b32 s65, v10, s64
    s_nop 1
    v_fmac_f32 v11, s65, v39
    s_add_u32 s64, s63, 24
    s_nop 0
    v_readlane_b32 s65, v10, s64
    s_nop 1
    v_fmac_f32 v11, s65, v40
    s_add_u32 s64, s63, 25
    s_nop 0
    v_readlane_b32 s65, v10, s64
    s_nop 1
    v_fmac_f32 v11, s65, v41
    s_add_u32 s64, s63, 26
    s_nop 0
    v_readlane_b32 s65, v10, s64
    s_nop 1
    v_fmac_f32 v11, s65, v42
    s_add_u32 s64, s63, 27
    s_nop 0
    v_readlane_b32 s65, v10, s64
    s_nop 1
    v_fmac_f32 v11, s65, v43
    s_add_u32 s64, s63, 28
    s_nop 0
    v_readlane_b32 s65, v10, s64
    s_nop 1
    v_fmac_f32 v11, s65, v44
    s_add_u32 s64, s63, 29
    s_nop 0
    v_readlane_b32 s65, v10, s64
    s_nop 1
    v_fmac_f32 v11, s65, v45
    s_add_u32 s64, s63, 30
    s_nop 0
    v_readlane_b32 s65, v10, s64
    s_nop 1
    v_fmac_f32 v11, s65, v46
    s_add_u32 s64, s63, 31
    s_nop 0
    v_readlane_b32 s65, v10, s64
    s_nop 1
    v_fmac_f32 v11, s65, v47
    v_lshlrev_b32 v3, 2, v0
    ds_write_b32 v3, v11 offset:16384
    s_waitcnt lgkmcnt(0)
    s_barrier
    v_cmp_gt_u32 vcc, 64, v0
    s_and_saveexec_b64 s[58:59], vcc
    ds_read_b32 v12, v3 offset:16384
    ds_read_b32 v13, v3 offset:16640
    ds_read_b32 v14, v3 offset:16896
    ds_read_b32 v15, v3 offset:17152
    s_waitcnt lgkmcnt(0)
    v_add_f32 v12, v12, v13
    v_add_f32 v14, v14, v15
    v_add_f32 v12, v12, v14
    ds_write_b32 v3, v12
    s_mov_b64 exec, s[58:59]
    s_waitcnt lgkmcnt(0)
    s_barrier
    v_lshrrev_b32 v1, 4, v0
    v_and_b32 v2, 15, v0
    v_lshlrev_b32 v4, 2, v1
    ds_read_b32 v24, v4 offset:0
    ds_read_b32 v25, v4 offset:64
    ds_read_b32 v26, v4 offset:128
    ds_read_b32 v27, v4 offset:192
    v_mov_b32 v28, 0
    v_mov_b32 v29, 0
    v_mov_b32 v30, 0
    v_mov_b32 v31, 0
    v_mov_b32 v32, 0
    v_mov_b32 v33, 0
    v_mov_b32 v34, 0
    v_mov_b32 v35, 0
    s_waitcnt vmcnt(0) lgkmcnt(0)
    v_lshlrev_b32 v36, 16, v108
    v_and_b32 v37, 0xffff0000, v108
    v_fmac_f32 v28, v36, v24
    v_fmac_f32 v29, v37, v24
    v_lshlrev_b32 v36, 16, v109
    v_and_b32 v37, 0xffff0000, v109
    v_fmac_f32 v30, v36, v24
    v_fmac_f32 v31, v37, v24
    v_lshlrev_b32 v36, 16, v110
    v_and_b32 v37, 0xffff0000, v110
    v_fmac_f32 v32, v36, v24
    v_fmac_f32 v33, v37, v24
    v_lshlrev_b32 v36, 16, v111
    v_and_b32 v37, 0xffff0000, v111
    v_fmac_f32 v34, v36, v24
    v_fmac_f32 v35, v37, v24
    v_lshlrev_b32 v36, 16, v112
    v_and_b32 v37, 0xffff0000, v112
    v_fmac_f32 v28, v36, v25
    v_fmac_f32 v29, v37, v25
    v_lshlrev_b32 v36, 16, v113
    v_and_b32 v37, 0xffff0000, v113
    v_fmac_f32 v30, v36, v25
    v_fmac_f32 v31, v37, v25
    v_lshlrev_b32 v36, 16, v114
    v_and_b32 v37, 0xffff0000, v114
    v_fmac_f32 v32, v36, v25
    v_fmac_f32 v33, v37, v25
    v_lshlrev_b32 v36, 16, v115
    v_and_b32 v37, 0xffff0000, v115
    v_fmac_f32 v34, v36, v25
    v_fmac_f32 v35, v37, v25
    v_lshlrev_b32 v36, 16, v116
    v_and_b32 v37, 0xffff0000, v116
    v_fmac_f32 v28, v36, v26
    v_fmac_f32 v29, v37, v26
    v_lshlrev_b32 v36, 16, v117
    v_and_b32 v37, 0xffff0000, v117
    v_fmac_f32 v30, v36, v26
    v_fmac_f32 v31, v37, v26
    v_lshlrev_b32 v36, 16, v118
    v_and_b32 v37, 0xffff0000, v118
    v_fmac_f32 v32, v36, v26
    v_fmac_f32 v33, v37, v26
    v_lshlrev_b32 v36, 16, v119
    v_and_b32 v37, 0xffff0000, v119
    v_fmac_f32 v34, v36, v26
    v_fmac_f32 v35, v37, v26
    v_lshlrev_b32 v36, 16, v120
    v_and_b32 v37, 0xffff0000, v120
    v_fmac_f32 v28, v36, v27
    v_fmac_f32 v29, v37, v27
    v_lshlrev_b32 v36, 16, v121
    v_and_b32 v37, 0xffff0000, v121
    v_fmac_f32 v30, v36, v27
    v_fmac_f32 v31, v37, v27
    v_lshlrev_b32 v36, 16, v122
    v_and_b32 v37, 0xffff0000, v122
    v_fmac_f32 v32, v36, v27
    v_fmac_f32 v33, v37, v27
    v_lshlrev_b32 v36, 16, v123
    v_and_b32 v37, 0xffff0000, v123
    v_fmac_f32 v34, v36, v27
    v_fmac_f32 v35, v37, v27
    v_lshlrev_b32 v4, 9, v1
    v_lshl_add_u32 v4, v2, 5, v4
    ds_write_b128 v4, v[28:31] offset:1024
    ds_write_b128 v4, v[32:35] offset:1040
    s_waitcnt lgkmcnt(0)
    s_barrier
    v_cmp_gt_u32 vcc, 128, v0
    s_and_saveexec_b64 s[58:59], vcc
    s_cbranch_execz k4_kernel_end
    v_lshlrev_b32 v4, 2, v0
    ds_read_b32 v8, v4 offset:1024
    ds_read_b32 v9, v4 offset:1536
    ds_read_b32 v10, v4 offset:2048
    ds_read_b32 v11, v4 offset:2560
    ds_read_b32 v12, v4 offset:3072
    ds_read_b32 v13, v4 offset:3584
    ds_read_b32 v14, v4 offset:4096
    ds_read_b32 v15, v4 offset:4608
    ds_read_b32 v16, v4 offset:5120
    ds_read_b32 v17, v4 offset:5632
    ds_read_b32 v18, v4 offset:6144
    ds_read_b32 v19, v4 offset:6656
    ds_read_b32 v20, v4 offset:7168
    ds_read_b32 v21, v4 offset:7680
    ds_read_b32 v22, v4 offset:8192
    ds_read_b32 v23, v4 offset:8704
    s_waitcnt lgkmcnt(0)
    v_add_f32 v8, v8, v16
    v_add_f32 v9, v9, v17
    v_add_f32 v10, v10, v18
    v_add_f32 v11, v11, v19
    v_add_f32 v12, v12, v20
    v_add_f32 v13, v13, v21
    v_add_f32 v14, v14, v22
    v_add_f32 v15, v15, v23
    v_add_f32 v8, v8, v12
    v_add_f32 v9, v9, v13
    v_add_f32 v10, v10, v14
    v_add_f32 v11, v11, v15
    v_add_f32 v8, v8, v10
    v_add_f32 v9, v9, v11
    v_add_f32 v8, v8, v9
    v_add_u32 v4, s55, v4
    buffer_store_dword v8, v4, s[48:51], 0 offen
k4_kernel_end:
    s_endpgm
.globl k5_kernel
.p2align 8
.type k5_kernel,@function
k5_kernel:
    s_cmp_ge_u32 s2, 256
    s_cbranch_scc1 k5_kernel_end
    s_load_dwordx16 s[16:31], s[0:1], 0
    s_load_dwordx8 s[32:39], s[0:1], 64
    s_load_dwordx4 s[40:43], s[0:1], 96
    s_waitcnt lgkmcnt(0)
    s_mov_b32 s48, s42
    s_mov_b32 s49, s43
    s_mov_b32 s50, 16777216
    s_mov_b32 s51, 0x00020000
    s_and_b32 s62, s2, 3
    s_lshr_b32 s61, s2, 2
    s_mov_b32 s44, s26
    s_mov_b32 s45, s27
    s_mov_b32 s46, 4194304
    s_mov_b32 s47, 0x00020000
    s_movk_i32 s52, 1024
    s_lshl_b32 s53, s61, 6
    s_lshl_b32 s54, s62, 8
    s_lshl_b32 s55, s61, 11
    s_lshl_b32 s63, s62, 9
    s_add_u32 s55, s55, s63
    s_add_u32 s55, s55, 1179648
    v_lshrrev_b32 v1, 4, v0
    v_and_b32 v2, 15, v0
    v_add_u32 v3, s53, v1
    v_mul_lo_u32 v3, v3, s52
    v_lshl_add_u32 v3, v2, 4, v3
    v_add_u32 v3, s54, v3
    s_lshl_b32 s56, s52, 4
    buffer_load_dwordx4 v[108:111], v3, s[44:47], 0 offen
    v_add_u32 v3, s56, v3
    buffer_load_dwordx4 v[112:115], v3, s[44:47], 0 offen
    v_add_u32 v3, s56, v3
    buffer_load_dwordx4 v[116:119], v3, s[44:47], 0 offen
    v_add_u32 v3, s56, v3
    buffer_load_dwordx4 v[120:123], v3, s[44:47], 0 offen
    v_add_u32 v5, s53, v0
    v_lshlrev_b32 v6, 2, v5
    v_add_u32 v6, 917504, v6
    buffer_load_dword v8, v6, s[48:51], 0 offen
    v_add_u32 v6, 16384, v6
    buffer_load_dword v9, v6, s[48:51], 0 offen
    v_add_u32 v6, 16384, v6
    buffer_load_dword v10, v6, s[48:51], 0 offen
    v_add_u32 v6, 16384, v6
    buffer_load_dword v11, v6, s[48:51], 0 offen
    v_add_u32 v6, 16384, v6
    buffer_load_dword v12, v6, s[48:51], 0 offen
    v_add_u32 v6, 16384, v6
    buffer_load_dword v13, v6, s[48:51], 0 offen
    v_add_u32 v6, 16384, v6
    buffer_load_dword v14, v6, s[48:51], 0 offen
    v_add_u32 v6, 16384, v6
    buffer_load_dword v15, v6, s[48:51], 0 offen
    s_waitcnt vmcnt(0)
    v_add_f32 v8, v8, v9
    v_add_f32 v8, v8, v10
    v_add_f32 v8, v8, v11
    v_add_f32 v8, v8, v12
    v_add_f32 v8, v8, v13
    v_add_f32 v8, v8, v14
    v_add_f32 v8, v8, v15
    v_cvt_pk_bf16_f32 v8, v8, v8
    v_lshlrev_b32 v8, 16, v8
    v_lshlrev_b32 v4, 2, v0
    v_cmp_gt_u32 vcc, 64, v0
    s_and_saveexec_b64 s[58:59], vcc
    ds_write_b32 v4, v8
    s_mov_b64 exec, s[58:59]
    s_waitcnt lgkmcnt(0)
    s_barrier
    v_lshrrev_b32 v1, 4, v0
    v_and_b32 v2, 15, v0
    v_lshlrev_b32 v4, 2, v1
    ds_read_b32 v24, v4 offset:0
    ds_read_b32 v25, v4 offset:64
    ds_read_b32 v26, v4 offset:128
    ds_read_b32 v27, v4 offset:192
    v_mov_b32 v28, 0
    v_mov_b32 v29, 0
    v_mov_b32 v30, 0
    v_mov_b32 v31, 0
    v_mov_b32 v32, 0
    v_mov_b32 v33, 0
    v_mov_b32 v34, 0
    v_mov_b32 v35, 0
    s_waitcnt vmcnt(0) lgkmcnt(0)
    v_lshlrev_b32 v36, 16, v108
    v_and_b32 v37, 0xffff0000, v108
    v_fmac_f32 v28, v36, v24
    v_fmac_f32 v29, v37, v24
    v_lshlrev_b32 v36, 16, v109
    v_and_b32 v37, 0xffff0000, v109
    v_fmac_f32 v30, v36, v24
    v_fmac_f32 v31, v37, v24
    v_lshlrev_b32 v36, 16, v110
    v_and_b32 v37, 0xffff0000, v110
    v_fmac_f32 v32, v36, v24
    v_fmac_f32 v33, v37, v24
    v_lshlrev_b32 v36, 16, v111
    v_and_b32 v37, 0xffff0000, v111
    v_fmac_f32 v34, v36, v24
    v_fmac_f32 v35, v37, v24
    v_lshlrev_b32 v36, 16, v112
    v_and_b32 v37, 0xffff0000, v112
    v_fmac_f32 v28, v36, v25
    v_fmac_f32 v29, v37, v25
    v_lshlrev_b32 v36, 16, v113
    v_and_b32 v37, 0xffff0000, v113
    v_fmac_f32 v30, v36, v25
    v_fmac_f32 v31, v37, v25
    v_lshlrev_b32 v36, 16, v114
    v_and_b32 v37, 0xffff0000, v114
    v_fmac_f32 v32, v36, v25
    v_fmac_f32 v33, v37, v25
    v_lshlrev_b32 v36, 16, v115
    v_and_b32 v37, 0xffff0000, v115
    v_fmac_f32 v34, v36, v25
    v_fmac_f32 v35, v37, v25
    v_lshlrev_b32 v36, 16, v116
    v_and_b32 v37, 0xffff0000, v116
    v_fmac_f32 v28, v36, v26
    v_fmac_f32 v29, v37, v26
    v_lshlrev_b32 v36, 16, v117
    v_and_b32 v37, 0xffff0000, v117
    v_fmac_f32 v30, v36, v26
    v_fmac_f32 v31, v37, v26
    v_lshlrev_b32 v36, 16, v118
    v_and_b32 v37, 0xffff0000, v118
    v_fmac_f32 v32, v36, v26
    v_fmac_f32 v33, v37, v26
    v_lshlrev_b32 v36, 16, v119
    v_and_b32 v37, 0xffff0000, v119
    v_fmac_f32 v34, v36, v26
    v_fmac_f32 v35, v37, v26
    v_lshlrev_b32 v36, 16, v120
    v_and_b32 v37, 0xffff0000, v120
    v_fmac_f32 v28, v36, v27
    v_fmac_f32 v29, v37, v27
    v_lshlrev_b32 v36, 16, v121
    v_and_b32 v37, 0xffff0000, v121
    v_fmac_f32 v30, v36, v27
    v_fmac_f32 v31, v37, v27
    v_lshlrev_b32 v36, 16, v122
    v_and_b32 v37, 0xffff0000, v122
    v_fmac_f32 v32, v36, v27
    v_fmac_f32 v33, v37, v27
    v_lshlrev_b32 v36, 16, v123
    v_and_b32 v37, 0xffff0000, v123
    v_fmac_f32 v34, v36, v27
    v_fmac_f32 v35, v37, v27
    v_lshlrev_b32 v4, 9, v1
    v_lshl_add_u32 v4, v2, 5, v4
    ds_write_b128 v4, v[28:31] offset:1024
    ds_write_b128 v4, v[32:35] offset:1040
    s_waitcnt lgkmcnt(0)
    s_barrier
    v_cmp_gt_u32 vcc, 128, v0
    s_and_saveexec_b64 s[58:59], vcc
    s_cbranch_execz k5_kernel_end
    v_lshlrev_b32 v4, 2, v0
    ds_read_b32 v8, v4 offset:1024
    ds_read_b32 v9, v4 offset:1536
    ds_read_b32 v10, v4 offset:2048
    ds_read_b32 v11, v4 offset:2560
    ds_read_b32 v12, v4 offset:3072
    ds_read_b32 v13, v4 offset:3584
    ds_read_b32 v14, v4 offset:4096
    ds_read_b32 v15, v4 offset:4608
    ds_read_b32 v16, v4 offset:5120
    ds_read_b32 v17, v4 offset:5632
    ds_read_b32 v18, v4 offset:6144
    ds_read_b32 v19, v4 offset:6656
    ds_read_b32 v20, v4 offset:7168
    ds_read_b32 v21, v4 offset:7680
    ds_read_b32 v22, v4 offset:8192
    ds_read_b32 v23, v4 offset:8704
    s_waitcnt lgkmcnt(0)
    v_add_f32 v8, v8, v16
    v_add_f32 v9, v9, v17
    v_add_f32 v10, v10, v18
    v_add_f32 v11, v11, v19
    v_add_f32 v12, v12, v20
    v_add_f32 v13, v13, v21
    v_add_f32 v14, v14, v22
    v_add_f32 v15, v15, v23
    v_add_f32 v8, v8, v12
    v_add_f32 v9, v9, v13
    v_add_f32 v10, v10, v14
    v_add_f32 v11, v11, v15
    v_add_f32 v8, v8, v10
    v_add_f32 v9, v9, v11
    v_add_f32 v8, v8, v9
    v_add_u32 v4, s55, v4
    buffer_store_dword v8, v4, s[48:51], 0 offen
k5_kernel_end:
    s_endpgm
.globl k6_kernel
.p2align 8
.type k6_kernel,@function
k6_kernel:
    s_cmp_ge_u32 s2, 2
    s_cbranch_scc1 k6_kernel_end
    s_load_dwordx16 s[16:31], s[0:1], 0
    s_load_dwordx8 s[32:39], s[0:1], 64
    s_load_dwordx4 s[40:43], s[0:1], 96
    s_waitcnt lgkmcnt(0)
    s_mov_b32 s48, s42
    s_mov_b32 s49, s43
    s_mov_b32 s50, 16777216
    s_mov_b32 s51, 0x00020000
    s_mov_b32 s44, s16
    s_mov_b32 s45, s17
    s_mov_b32 s46, 1024
    s_mov_b32 s47, 0x00020000
    s_mov_b32 s60, s36
    s_mov_b32 s61, s37
    s_mov_b32 s62, 1024
    s_mov_b32 s63, 0x00020000
    s_mov_b32 s64, s38
    s_mov_b32 s65, s39
    s_mov_b32 s66, 1024
    s_mov_b32 s67, 0x00020000
    v_and_b32 v2, 63, v0
    v_lshlrev_b32 v3, 4, v2
    buffer_load_dwordx4 v[4:7], v3, s[44:47], 0 offen
    buffer_load_dwordx4 v[8:11], v3, s[60:63], 0 offen
    s_lshl_b32 s3, s2, 8
    v_add_u32 v1, s3, v0
    v_lshlrev_b32 v12, 2, v1
    v_add_u32 v13, 1179648, v12
    buffer_load_dword v32, v13, s[48:51], 0 offen
    buffer_load_dword v33, v13, s[48:51], 0 offen offset:2048
    v_add_u32 v13, 4096, v13
    buffer_load_dword v34, v13, s[48:51], 0 offen
    buffer_load_dword v35, v13, s[48:51], 0 offen offset:2048
    v_add_u32 v13, 4096, v13
    buffer_load_dword v36, v13, s[48:51], 0 offen
    buffer_load_dword v37, v13, s[48:51], 0 offen offset:2048
    v_add_u32 v13, 4096, v13
    buffer_load_dword v38, v13, s[48:51], 0 offen
    buffer_load_dword v39, v13, s[48:51], 0 offen offset:2048
    v_add_u32 v13, 4096, v13
    buffer_load_dword v40, v13, s[48:51], 0 offen
    buffer_load_dword v41, v13, s[48:51], 0 offen offset:2048
    v_add_u32 v13, 4096, v13
    buffer_load_dword v42, v13, s[48:51], 0 offen
    buffer_load_dword v43, v13, s[48:51], 0 offen offset:2048
    v_add_u32 v13, 4096, v13
    buffer_load_dword v44, v13, s[48:51], 0 offen
    buffer_load_dword v45, v13, s[48:51], 0 offen offset:2048
    v_add_u32 v13, 4096, v13
    buffer_load_dword v46, v13, s[48:51], 0 offen
    buffer_load_dword v47, v13, s[48:51], 0 offen offset:2048
    v_add_u32 v13, 4096, v13
    buffer_load_dword v48, v13, s[48:51], 0 offen
    buffer_load_dword v49, v13, s[48:51], 0 offen offset:2048
    v_add_u32 v13, 4096, v13
    buffer_load_dword v50, v13, s[48:51], 0 offen
    buffer_load_dword v51, v13, s[48:51], 0 offen offset:2048
    v_add_u32 v13, 4096, v13
    buffer_load_dword v52, v13, s[48:51], 0 offen
    buffer_load_dword v53, v13, s[48:51], 0 offen offset:2048
    v_add_u32 v13, 4096, v13
    buffer_load_dword v54, v13, s[48:51], 0 offen
    buffer_load_dword v55, v13, s[48:51], 0 offen offset:2048
    v_add_u32 v13, 4096, v13
    buffer_load_dword v56, v13, s[48:51], 0 offen
    buffer_load_dword v57, v13, s[48:51], 0 offen offset:2048
    v_add_u32 v13, 4096, v13
    buffer_load_dword v58, v13, s[48:51], 0 offen
    buffer_load_dword v59, v13, s[48:51], 0 offen offset:2048
    v_add_u32 v13, 4096, v13
    buffer_load_dword v60, v13, s[48:51], 0 offen
    buffer_load_dword v61, v13, s[48:51], 0 offen offset:2048
    v_add_u32 v13, 4096, v13
    buffer_load_dword v62, v13, s[48:51], 0 offen
    buffer_load_dword v63, v13, s[48:51], 0 offen offset:2048
    v_add_u32 v13, 4096, v13
    buffer_load_dword v64, v13, s[48:51], 0 offen
    buffer_load_dword v65, v13, s[48:51], 0 offen offset:2048
    v_add_u32 v13, 4096, v13
    buffer_load_dword v66, v13, s[48:51], 0 offen
    buffer_load_dword v67, v13, s[48:51], 0 offen offset:2048
    v_add_u32 v13, 4096, v13
    buffer_load_dword v68, v13, s[48:51], 0 offen
    buffer_load_dword v69, v13, s[48:51], 0 offen offset:2048
    v_add_u32 v13, 4096, v13
    buffer_load_dword v70, v13, s[48:51], 0 offen
    buffer_load_dword v71, v13, s[48:51], 0 offen offset:2048
    v_add_u32 v13, 4096, v13
    buffer_load_dword v72, v13, s[48:51], 0 offen
    buffer_load_dword v73, v13, s[48:51], 0 offen offset:2048
    v_add_u32 v13, 4096, v13
    buffer_load_dword v74, v13, s[48:51], 0 offen
    buffer_load_dword v75, v13, s[48:51], 0 offen offset:2048
    v_add_u32 v13, 4096, v13
    buffer_load_dword v76, v13, s[48:51], 0 offen
    buffer_load_dword v77, v13, s[48:51], 0 offen offset:2048
    v_add_u32 v13, 4096, v13
    buffer_load_dword v78, v13, s[48:51], 0 offen
    buffer_load_dword v79, v13, s[48:51], 0 offen offset:2048
    v_add_u32 v13, 4096, v13
    buffer_load_dword v80, v13, s[48:51], 0 offen
    buffer_load_dword v81, v13, s[48:51], 0 offen offset:2048
    v_add_u32 v13, 4096, v13
    buffer_load_dword v82, v13, s[48:51], 0 offen
    buffer_load_dword v83, v13, s[48:51], 0 offen offset:2048
    v_add_u32 v13, 4096, v13
    buffer_load_dword v84, v13, s[48:51], 0 offen
    buffer_load_dword v85, v13, s[48:51], 0 offen offset:2048
    v_add_u32 v13, 4096, v13
    buffer_load_dword v86, v13, s[48:51], 0 offen
    buffer_load_dword v87, v13, s[48:51], 0 offen offset:2048
    v_add_u32 v13, 4096, v13
    buffer_load_dword v88, v13, s[48:51], 0 offen
    buffer_load_dword v89, v13, s[48:51], 0 offen offset:2048
    v_add_u32 v13, 4096, v13
    buffer_load_dword v90, v13, s[48:51], 0 offen
    buffer_load_dword v91, v13, s[48:51], 0 offen offset:2048
    v_add_u32 v13, 4096, v13
    buffer_load_dword v92, v13, s[48:51], 0 offen
    buffer_load_dword v93, v13, s[48:51], 0 offen offset:2048
    v_add_u32 v13, 4096, v13
    buffer_load_dword v94, v13, s[48:51], 0 offen
    buffer_load_dword v95, v13, s[48:51], 0 offen offset:2048
    v_add_u32 v13, 655360, v12
    s_waitcnt vmcnt(40)
    buffer_load_dword v100, v13, s[48:51], 0 offen
    buffer_load_dword v101, v13, s[48:51], 0 offen offset:2048
    v_add_u32 v13, 4096, v13
    buffer_load_dword v102, v13, s[48:51], 0 offen
    buffer_load_dword v103, v13, s[48:51], 0 offen offset:2048
    v_add_u32 v13, 4096, v13
    buffer_load_dword v104, v13, s[48:51], 0 offen
    buffer_load_dword v105, v13, s[48:51], 0 offen offset:2048
    v_add_u32 v13, 4096, v13
    buffer_load_dword v106, v13, s[48:51], 0 offen
    buffer_load_dword v107, v13, s[48:51], 0 offen offset:2048
    v_add_u32 v13, 4096, v13
    buffer_load_dword v108, v13, s[48:51], 0 offen
    buffer_load_dword v109, v13, s[48:51], 0 offen offset:2048
    v_add_u32 v13, 4096, v13
    buffer_load_dword v110, v13, s[48:51], 0 offen
    buffer_load_dword v111, v13, s[48:51], 0 offen offset:2048
    v_add_u32 v13, 4096, v13
    buffer_load_dword v112, v13, s[48:51], 0 offen
    buffer_load_dword v113, v13, s[48:51], 0 offen offset:2048
    v_add_u32 v13, 4096, v13
    buffer_load_dword v114, v13, s[48:51], 0 offen
    buffer_load_dword v115, v13, s[48:51], 0 offen offset:2048
    v_add_u32 v13, 4096, v13
    buffer_load_dword v116, v13, s[48:51], 0 offen
    buffer_load_dword v117, v13, s[48:51], 0 offen offset:2048
    v_add_u32 v13, 4096, v13
    buffer_load_dword v118, v13, s[48:51], 0 offen
    buffer_load_dword v119, v13, s[48:51], 0 offen offset:2048
    v_add_u32 v13, 4096, v13
    buffer_load_dword v120, v13, s[48:51], 0 offen
    buffer_load_dword v121, v13, s[48:51], 0 offen offset:2048
    v_mov_b32 v14, 0
    v_lshlrev_b32 v15, 16, v4
    v_lshlrev_b32 v16, 16, v8
    v_mul_f32 v15, v15, v16
    v_cvt_pk_bf16_f32 v15, v15, v15
    v_lshlrev_b32 v15, 16, v15
    v_add_f32 v14, v14, v15
    v_and_b32 v15, 0xffff0000, v4
    v_and_b32 v16, 0xffff0000, v8
    v_mul_f32 v15, v15, v16
    v_cvt_pk_bf16_f32 v15, v15, v15
    v_lshlrev_b32 v15, 16, v15
    v_add_f32 v14, v14, v15
    v_lshlrev_b32 v15, 16, v5
    v_lshlrev_b32 v16, 16, v9
    v_mul_f32 v15, v15, v16
    v_cvt_pk_bf16_f32 v15, v15, v15
    v_lshlrev_b32 v15, 16, v15
    v_add_f32 v14, v14, v15
    v_and_b32 v15, 0xffff0000, v5
    v_and_b32 v16, 0xffff0000, v9
    v_mul_f32 v15, v15, v16
    v_cvt_pk_bf16_f32 v15, v15, v15
    v_lshlrev_b32 v15, 16, v15
    v_add_f32 v14, v14, v15
    v_lshlrev_b32 v15, 16, v6
    v_lshlrev_b32 v16, 16, v10
    v_mul_f32 v15, v15, v16
    v_cvt_pk_bf16_f32 v15, v15, v15
    v_lshlrev_b32 v15, 16, v15
    v_add_f32 v14, v14, v15
    v_and_b32 v15, 0xffff0000, v6
    v_and_b32 v16, 0xffff0000, v10
    v_mul_f32 v15, v15, v16
    v_cvt_pk_bf16_f32 v15, v15, v15
    v_lshlrev_b32 v15, 16, v15
    v_add_f32 v14, v14, v15
    v_lshlrev_b32 v15, 16, v7
    v_lshlrev_b32 v16, 16, v11
    v_mul_f32 v15, v15, v16
    v_cvt_pk_bf16_f32 v15, v15, v15
    v_lshlrev_b32 v15, 16, v15
    v_add_f32 v14, v14, v15
    v_and_b32 v15, 0xffff0000, v7
    v_and_b32 v16, 0xffff0000, v11
    v_mul_f32 v15, v15, v16
    v_cvt_pk_bf16_f32 v15, v15, v15
    v_lshlrev_b32 v15, 16, v15
    v_add_f32 v14, v14, v15
    s_nop 1
    v_add_f32_dpp v14, v14, v14 row_ror:8 row_mask:0xf bank_mask:0xf
    s_nop 1
    v_add_f32_dpp v14, v14, v14 row_ror:4 row_mask:0xf bank_mask:0xf
    s_nop 1
    v_add_f32_dpp v14, v14, v14 row_ror:2 row_mask:0xf bank_mask:0xf
    s_nop 1
    v_add_f32_dpp v14, v14, v14 row_ror:1 row_mask:0xf bank_mask:0xf
    s_nop 1
    v_readlane_b32 s4, v14, 0
    v_readlane_b32 s5, v14, 16
    v_readlane_b32 s6, v14, 32
    v_readlane_b32 s7, v14, 48
    s_nop 1
    v_mov_b32 v14, s4
    v_add_f32 v14, s5, v14
    v_add_f32 v14, s6, v14
    v_add_f32 v14, s7, v14
    v_cvt_pk_bf16_f32 v14, v14, v14
    v_lshlrev_b32 v14, 16, v14
    v_mul_f32 v14, 0xbfb8aa3b, v14
    v_exp_f32 v14, v14
    s_nop 0
    v_add_f32 v14, 1.0, v14
    v_rcp_f32 v14, v14
    s_nop 0
    v_cvt_pk_bf16_f32 v14, v14, v14
    v_lshlrev_b32 v14, 16, v14
    s_waitcnt vmcnt(0)
    v_add_f32 v32, v32, v64
    v_add_f32 v33, v33, v65
    v_add_f32 v34, v34, v66
    v_add_f32 v35, v35, v67
    v_add_f32 v36, v36, v68
    v_add_f32 v37, v37, v69
    v_add_f32 v38, v38, v70
    v_add_f32 v39, v39, v71
    v_add_f32 v40, v40, v72
    v_add_f32 v41, v41, v73
    v_add_f32 v42, v42, v74
    v_add_f32 v43, v43, v75
    v_add_f32 v44, v44, v76
    v_add_f32 v45, v45, v77
    v_add_f32 v46, v46, v78
    v_add_f32 v47, v47, v79
    v_add_f32 v48, v48, v80
    v_add_f32 v49, v49, v81
    v_add_f32 v50, v50, v82
    v_add_f32 v51, v51, v83
    v_add_f32 v52, v52, v84
    v_add_f32 v53, v53, v85
    v_add_f32 v54, v54, v86
    v_add_f32 v55, v55, v87
    v_add_f32 v56, v56, v88
    v_add_f32 v57, v57, v89
    v_add_f32 v58, v58, v90
    v_add_f32 v59, v59, v91
    v_add_f32 v60, v60, v92
    v_add_f32 v61, v61, v93
    v_add_f32 v62, v62, v94
    v_add_f32 v63, v63, v95
    v_add_f32 v32, v32, v48
    v_add_f32 v33, v33, v49
    v_add_f32 v34, v34, v50
    v_add_f32 v35, v35, v51
    v_add_f32 v36, v36, v52
    v_add_f32 v37, v37, v53
    v_add_f32 v38, v38, v54
    v_add_f32 v39, v39, v55
    v_add_f32 v40, v40, v56
    v_add_f32 v41, v41, v57
    v_add_f32 v42, v42, v58
    v_add_f32 v43, v43, v59
    v_add_f32 v44, v44, v60
    v_add_f32 v45, v45, v61
    v_add_f32 v46, v46, v62
    v_add_f32 v47, v47, v63
    v_add_f32 v32, v32, v40
    v_add_f32 v33, v33, v41
    v_add_f32 v34, v34, v42
    v_add_f32 v35, v35, v43
    v_add_f32 v36, v36, v44
    v_add_f32 v37, v37, v45
    v_add_f32 v38, v38, v46
    v_add_f32 v39, v39, v47
    v_add_f32 v32, v32, v36
    v_add_f32 v33, v33, v37
    v_add_f32 v34, v34, v38
    v_add_f32 v35, v35, v39
    v_add_f32 v32, v32, v34
    v_add_f32 v33, v33, v35
    v_add_f32 v32, v32, v33
    v_cvt_pk_bf16_f32 v32, v32, v32
    v_lshlrev_b32 v32, 16, v32
    v_add_f32 v100, v100, v101
    v_add_f32 v100, v100, v102
    v_add_f32 v100, v100, v103
    v_add_f32 v100, v100, v104
    v_add_f32 v100, v100, v105
    v_add_f32 v100, v100, v106
    v_add_f32 v100, v100, v107
    v_add_f32 v100, v100, v108
    v_add_f32 v100, v100, v109
    v_add_f32 v100, v100, v110
    v_add_f32 v100, v100, v111
    v_add_f32 v100, v100, v112
    v_add_f32 v100, v100, v113
    v_add_f32 v100, v100, v114
    v_add_f32 v100, v100, v115
    v_add_f32 v100, v100, v116
    v_add_f32 v100, v100, v117
    v_add_f32 v100, v100, v118
    v_add_f32 v100, v100, v119
    v_add_f32 v100, v100, v120
    v_add_f32 v100, v100, v121
    v_mov_b32 v40, v100
    v_cvt_pk_bf16_f32 v40, v40, v40
    v_lshlrev_b32 v40, 16, v40
    v_mul_f32 v32, v14, v32
    v_cvt_pk_bf16_f32 v32, v32, v32
    v_lshlrev_b32 v32, 16, v32
    v_sub_f32 v15, 1.0, v14
    v_cvt_pk_bf16_f32 v15, v15, v15
    v_lshlrev_b32 v15, 16, v15
    v_mul_f32 v40, v15, v40
    v_cvt_pk_bf16_f32 v40, v40, v40
    v_lshlrev_b32 v40, 16, v40
    v_add_f32 v32, v32, v40
    v_cvt_pk_bf16_f32 v32, v32, v32
    v_lshlrev_b32 v12, 1, v1
    buffer_store_short v32, v12, s[64:67], 0 offen
k6_kernel_end:
    s_endpgm
.section .rodata,"a"
.p2align 6
.amdhsa_kernel ka_kernel
  .amdhsa_next_free_vgpr 256
  .amdhsa_next_free_sgpr 96
  .amdhsa_accum_offset 256
  .amdhsa_group_segment_fixed_size 0
  .amdhsa_kernarg_size 112
  .amdhsa_user_sgpr_count 2
  .amdhsa_user_sgpr_kernarg_segment_ptr 1
  .amdhsa_system_sgpr_workgroup_id_x 1
.end_amdhsa_kernel
.p2align 6
.amdhsa_kernel k3_kernel
  .amdhsa_next_free_vgpr 256
  .amdhsa_next_free_sgpr 96
  .amdhsa_accum_offset 256
  .amdhsa_group_segment_fixed_size 0
  .amdhsa_kernarg_size 112
  .amdhsa_user_sgpr_count 2
  .amdhsa_user_sgpr_kernarg_segment_ptr 1
  .amdhsa_system_sgpr_workgroup_id_x 1
.end_amdhsa_kernel
.p2align 6
.amdhsa_kernel k4_kernel
  .amdhsa_next_free_vgpr 256
  .amdhsa_next_free_sgpr 96
  .amdhsa_accum_offset 256
  .amdhsa_group_segment_fixed_size 0
  .amdhsa_kernarg_size 112
  .amdhsa_user_sgpr_count 2
  .amdhsa_user_sgpr_kernarg_segment_ptr 1
  .amdhsa_system_sgpr_workgroup_id_x 1
.end_amdhsa_kernel
.p2align 6
.amdhsa_kernel k5_kernel
  .amdhsa_next_free_vgpr 256
  .amdhsa_next_free_sgpr 96
  .amdhsa_accum_offset 256
  .amdhsa_group_segment_fixed_size 0
  .amdhsa_kernarg_size 112
  .amdhsa_user_sgpr_count 2
  .amdhsa_user_sgpr_kernarg_segment_ptr 1
  .amdhsa_system_sgpr_workgroup_id_x 1
.end_amdhsa_kernel
.p2align 6
.amdhsa_kernel k6_kernel
  .amdhsa_next_free_vgpr 256
  .amdhsa_next_free_sgpr 96
  .amdhsa_accum_offset 256
  .amdhsa_group_segment_fixed_size 0
  .amdhsa_kernarg_size 112
  .amdhsa_user_sgpr_count 2
  .amdhsa_user_sgpr_kernarg_segment_ptr 1
  .amdhsa_system_sgpr_workgroup_id_x 1
.end_amdhsa_kernel
```
